```python
import torch

def _softmax(x, axis=-1):
    return torch.softmax(x, dim=axis)
def _gelu(x):
    return torch.nn.functional.gelu(x, approximate="tanh")
def _silu(x):
    return torch.nn.functional.silu(x)
def _sigmoid(x):
    return torch.sigmoid(x)
def _layernorm(x, axis=-1, eps=1e-5):
    m = x.mean(dim=axis, keepdim=True)
    v = x.var(dim=axis, keepdim=True, unbiased=False)
    return (x - m) / torch.sqrt(v + eps)
def _scatter_add(tgt, idx, src, axis=0):
    return tgt.clone().index_add_(axis, idx, src)
def _segment_sum(src, seg, n):
    out = torch.zeros((n,) + src.shape[1:], dtype=src.dtype)
    return out.index_add_(0, seg, src)
def _pad(x, pw):
    flat = tuple(v for pair in reversed(pw) for v in pair)
    return torch.nn.functional.pad(x, flat)

kernel_name = 'gated_mix__softmax_full_mha__dense_activation_squared_relu__prompt'

def setup_inputs():

    _w = (lambda a: (lambda t: t.to(torch.bfloat16) if t.is_floating_point() else t)(torch.as_tensor(a)))
    def _A_setup():
        B, S, D = 1, 2048, 576
        return {
            "x": _w((lambda *s: torch.randn(*s, dtype=torch.bfloat16) * 0.05)(B, S, D)),
            "wqkv": _w((lambda *s: torch.randn(*s, dtype=torch.bfloat16) * 0.8)(D, 3 * D)),
            "wo": _w((lambda *s: torch.randn(*s, dtype=torch.bfloat16) * 0.1)(D, D)),
        }
    _A_in = _A_setup()

    def _B_setup():
        B, S, D, F = 1, 2048, 576, 4608
        return {
            "x": _w((lambda *s: torch.randn(*s, dtype=torch.bfloat16) * 0.05)(B, S, D)),
            "w1": _w((lambda *s: torch.randn(*s, dtype=torch.bfloat16) * 0.05)(D, F)),
            "b1": _w((lambda *s: torch.randn(*s, dtype=torch.bfloat16) * 0.05)(F)),
            "w2": _w((lambda *s: torch.randn(*s, dtype=torch.bfloat16) * 0.05)(F, D)),
            "b2": _w((lambda *s: torch.randn(*s, dtype=torch.bfloat16) * 0.05)(D)),
        }
    _B_in = _B_setup()

    return {
        "A_x": _A_in["x"],
        "A_wqkv": _A_in["wqkv"],
        "A_wo": _A_in["wo"],
        "B_x": _B_in["x"],
        "B_w1": _B_in["w1"],
        "B_b1": _B_in["b1"],
        "B_w2": _B_in["w2"],
        "B_b2": _B_in["b2"],
        "gate_w": _w((lambda *s: torch.randn(*s, dtype=torch.bfloat16) * 0.05)(576) * 16.0),
    }

def reference(A_x, A_wqkv, A_wo, B_x, B_w1, B_b1, B_w2, B_b2, gate_w):
    def _A_ref(x, wqkv, wo):
        B, S, D = x.shape
        H = 32; Dh = D // H
        qkv = (lambda x, *d: x.permute(*d))((x @ wqkv).reshape(B, S, 3, H, Dh), 2, 0, 3, 1, 4)
        q, k, v = qkv[0], qkv[1], qkv[2]
        scale = Dh ** -0.5
        scores = torch.einsum("bhqd,bhkd->bhqk", q, k) * scale
        p = _softmax(scores, axis=-1)
        o = torch.einsum("bhqk,bhkd->bhqd", p, v)
        return (lambda x, *d: x.permute(*d))(o, 0, 2, 1, 3).reshape(B, S, D) @ wo

    def _B_ref(x, w1, b1, w2, b2):
        h = torch.einsum("bsd,df->bsf", x, w1) + b1
        zero = torch.zeros_like(h)
        r = torch.where(h > zero, h, zero)
        h = r * r
        out = torch.einsum("bsf,fd->bsd", h, w2) + b2
        return out

    x = A_x
    g = _sigmoid((x * gate_w).sum(-1, keepdims=True))
    a = _A_ref(x, A_wqkv, A_wo)
    b = _B_ref(x, B_w1, B_b1, B_w2, B_b2)
    return g * a + (1 - g) * b
```

```asm
; @launch kernel=k1_kernel grid=(256,1,1) block=(512,1,1) lds=155648
; @launch kernel=k2_kernel grid=(505,1,1) block=(256,1,1) lds=61440
; @launch kernel=k3_kernel grid=(192,1,1) block=(384,1,1) lds=147456
.amdgcn_target "amdgcn-amd-amdhsa--gfx950"
.text
.globl k1_kernel
.p2align 8
.type k1_kernel,@function
k1_kernel:
    s_cmp_ge_u32 s2, 256
    s_cbranch_scc1 k1_end
    s_and_b32 s4, s2, 7
    s_lshr_b32 s5, s2, 3
    s_and_b32 s6, s4, 1
    s_lshl_b32 s6, s6, 2
    s_and_b32 s7, s5, 3
    s_add_u32 s25, s6, s7
    s_lshr_b32 s6, s4, 1
    s_lshl_b32 s6, s6, 3
    s_lshr_b32 s7, s5, 2
    s_add_u32 s26, s6, s7
    v_lshrrev_b32 v2, 6, v0
    v_and_b32 v1, 63, v0
    s_nop 0
    v_readfirstlane_b32 s24, v2
    v_lshlrev_b32 v15, 4, v1
    s_load_dwordx2 s[16:17], s[0:1], 88
    s_mov_b32 s18, 42942464
    s_mov_b32 s19, 0x00020000
    s_load_dwordx2 s[44:45], s[0:1], 48
    s_mov_b32 s46, 5308416
    s_mov_b32 s47, 0x00020000
    s_lshl_b32 s32, s25, 3
    s_add_u32 s32, s32, s24
    s_cmp_ge_u32 s26, 24
    s_cbranch_scc1 k1_qkv
    s_load_dwordx2 s[8:9], s[0:1], 0
    s_mov_b32 s10, 2359296
    s_mov_b32 s11, 0x00020000
    s_load_dwordx2 s[12:13], s[0:1], 32
    s_mov_b32 s14, 5308416
    s_mov_b32 s15, 0x00020000
    s_load_dwordx2 s[20:21], s[0:1], 40
    s_mov_b32 s22, 9216
    s_mov_b32 s23, 0x00020000
    s_branch k1_go
k1_qkv:
    s_load_dwordx2 s[8:9], s[0:1], 0
    s_mov_b32 s10, 2359296
    s_mov_b32 s11, 0x00020000
    s_load_dwordx2 s[12:13], s[0:1], 8
    s_mov_b32 s14, 1990656
    s_mov_b32 s15, 0x00020000
    s_load_dwordx2 s[20:21], s[0:1], 64
    s_mov_b32 s22, 1152
    s_mov_b32 s23, 0x00020000
k1_go:
    s_and_b32 s39, s24, 1
    s_lshr_b32 s41, s24, 1
    s_lshl_b32 s41, s41, 1
    s_lshl_b32 s4, s25, 3
    s_add_u32 s41, s41, s4
    v_lshrrev_b32 v64, 2, v1
    v_add_u32 v64, 0, v64
    v_bfe_u32 v65, v64, 2, 2
    v_and_b32 v66, 3, v1
    v_xor_b32 v65, v65, v66
    s_lshl_b32 s4, s32, 5
    v_add_u32 v64, s4, v64
    v_mul_u32_u24 v64, 1152, v64
    v_lshl_add_u32 v4, v65, 4, v64
    v_lshrrev_b32 v64, 2, v1
    v_add_u32 v64, 16, v64
    v_bfe_u32 v65, v64, 2, 2
    v_and_b32 v66, 3, v1
    v_xor_b32 v65, v65, v66
    s_lshl_b32 s4, s32, 5
    v_add_u32 v64, s4, v64
    v_mul_u32_u24 v64, 1152, v64
    v_lshl_add_u32 v5, v65, 4, v64
    s_waitcnt lgkmcnt(0)
    s_and_b32 s9, s9, 0xffff
    s_and_b32 s13, s13, 0xffff
    s_and_b32 s17, s17, 0xffff
    s_and_b32 s21, s21, 0xffff
    s_and_b32 s45, s45, 0xffff
    s_sub_u32 s35, s26, 24
    s_mul_i32 s31, s35, 6
    s_sub_u32 s4, s35, 2
    s_cmp_lt_u32 s35, 4
    s_cselect_b32 s36, s35, s4
    s_cmp_lt_u32 s26, 24
    s_cbranch_scc1 k1_ffn
    s_cmp_lt_u32 s26, 28
    s_cbranch_scc1 k1_qkl
    s_cmp_eq_u32 s26, 28
    s_cbranch_scc1 k1_qkg
    s_cmp_eq_u32 s26, 29
    s_cbranch_scc1 k1_mix
    s_branch k1_vl
k1_ffn:
    s_add_u32 s4, s24, 0
    s_lshl_b32 s4, s4, 6
    v_add_u32 v64, s4, v1
    s_mov_b32 s5, 2731
    v_mul_lo_u32 v65, v64, s5
    v_lshrrev_b32 v65, 16, v65
    v_mul_u32_u24 v66, 24, v65
    v_sub_u32 v66, v64, v66
    v_lshlrev_b32 v67, 1, v65
    v_and_b32 v67, 4, v67
    v_xor_b32 v66, v66, v67
    v_lshlrev_b32 v66, 4, v66
    v_mul_u32_u24 v65, 9216, v65
    s_mul_i32 s4, s26, 384
    v_add3_u32 v6, v65, v66, s4
    s_add_u32 s4, s24, 8
    s_lshl_b32 s4, s4, 6
    v_add_u32 v64, s4, v1
    s_mov_b32 s5, 2731
    v_mul_lo_u32 v65, v64, s5
    v_lshrrev_b32 v65, 16, v65
    v_mul_u32_u24 v66, 24, v65
    v_sub_u32 v66, v64, v66
    v_lshlrev_b32 v67, 1, v65
    v_and_b32 v67, 4, v67
    v_xor_b32 v66, v66, v67
    v_lshlrev_b32 v66, 4, v66
    v_mul_u32_u24 v65, 9216, v65
    s_mul_i32 s4, s26, 384
    v_add3_u32 v7, v65, v66, s4
    s_lshl_b32 s33, s24, 11
    s_lshl_b32 s34, s24, 10
    s_add_u32 s34, s34, 16384
    s_lshl_b32 s37, s24, 8
    s_add_u32 s37, s37, 28672
    s_mov_b32 s28, 0
    s_mov_b32 s29, 0
    s_mov_b32 s30, 0
    s_mov_b32 s38, 0
    v_lshrrev_b32 v64, 5, v1
    v_lshlrev_b32 v64, 3, v64
    s_mul_i32 s4, s26, 384
    s_lshl_b32 s5, s39, 6
    s_add_u32 s4, s4, s5
    v_add_u32 v64, s4, v64
    buffer_load_dwordx2 v[72:73], v64, s[20:23], 0 offen offset:0
    buffer_load_dwordx2 v[74:75], v64, s[20:23], 0 offen offset:16
    buffer_load_dwordx2 v[76:77], v64, s[20:23], 0 offen offset:32
    buffer_load_dwordx2 v[78:79], v64, s[20:23], 0 offen offset:48
    buffer_load_dwordx2 v[80:81], v64, s[20:23], 0 offen offset:128
    buffer_load_dwordx2 v[82:83], v64, s[20:23], 0 offen offset:144
    buffer_load_dwordx2 v[84:85], v64, s[20:23], 0 offen offset:160
    buffer_load_dwordx2 v[86:87], v64, s[20:23], 0 offen offset:176
    buffer_load_dwordx2 v[88:89], v64, s[20:23], 0 offen offset:256
    buffer_load_dwordx2 v[90:91], v64, s[20:23], 0 offen offset:272
    buffer_load_dwordx2 v[92:93], v64, s[20:23], 0 offen offset:288
    buffer_load_dwordx2 v[94:95], v64, s[20:23], 0 offen offset:304
    s_add_u32 m0, s30, s33
    s_nop 0
    buffer_load_dwordx4 v4, s[8:11], s28 offen lds
    s_add_u32 m0, m0, 1024
    s_nop 0
    buffer_load_dwordx4 v5, s[8:11], s28 offen lds
    s_add_u32 m0, s30, s34
    s_nop 0
    buffer_load_dwordx4 v6, s[12:15], s29 offen lds
    s_cmp_ge_u32 s24, 4
    s_cbranch_scc1 w2_1
    s_add_u32 m0, m0, 8192
    s_nop 0
    buffer_load_dwordx4 v7, s[12:15], s29 offen lds
w2_1:
    s_add_u32 s28, s28, 64
    s_add_u32 s29, s29, 294912
    s_add_u32 s38, s38, 1
    s_cmp_ge_u32 s38, 18
    s_cselect_b32 s28, 0x40000000, s28
    s_cselect_b32 s29, 0x40000000, s29
    s_add_u32 s30, s30, 30720
    s_cmp_eq_u32 s30, 153600
    s_cselect_b32 s30, 0, s30
    s_add_u32 m0, s30, s33
    s_nop 0
    buffer_load_dwordx4 v4, s[8:11], s28 offen lds
    s_add_u32 m0, m0, 1024
    s_nop 0
    buffer_load_dwordx4 v5, s[8:11], s28 offen lds
    s_add_u32 m0, s30, s34
    s_nop 0
    buffer_load_dwordx4 v6, s[12:15], s29 offen lds
    s_cmp_ge_u32 s24, 4
    s_cbranch_scc1 w2_2
    s_add_u32 m0, m0, 8192
    s_nop 0
    buffer_load_dwordx4 v7, s[12:15], s29 offen lds
w2_2:
    s_add_u32 s28, s28, 64
    s_add_u32 s29, s29, 294912
    s_add_u32 s38, s38, 1
    s_cmp_ge_u32 s38, 18
    s_cselect_b32 s28, 0x40000000, s28
    s_cselect_b32 s29, 0x40000000, s29
    s_add_u32 s30, s30, 30720
    s_cmp_eq_u32 s30, 153600
    s_cselect_b32 s30, 0, s30
    s_add_u32 m0, s30, s33
    s_nop 0
    buffer_load_dwordx4 v4, s[8:11], s28 offen lds
    s_add_u32 m0, m0, 1024
    s_nop 0
    buffer_load_dwordx4 v5, s[8:11], s28 offen lds
    s_add_u32 m0, s30, s34
    s_nop 0
    buffer_load_dwordx4 v6, s[12:15], s29 offen lds
    s_cmp_ge_u32 s24, 4
    s_cbranch_scc1 w2_3
    s_add_u32 m0, m0, 8192
    s_nop 0
    buffer_load_dwordx4 v7, s[12:15], s29 offen lds
w2_3:
    s_add_u32 s28, s28, 64
    s_add_u32 s29, s29, 294912
    s_add_u32 s38, s38, 1
    s_cmp_ge_u32 s38, 18
    s_cselect_b32 s28, 0x40000000, s28
    s_cselect_b32 s29, 0x40000000, s29
    s_add_u32 s30, s30, 30720
    s_cmp_eq_u32 s30, 153600
    s_cselect_b32 s30, 0, s30
    s_add_u32 m0, s30, s33
    s_nop 0
    buffer_load_dwordx4 v4, s[8:11], s28 offen lds
    s_add_u32 m0, m0, 1024
    s_nop 0
    buffer_load_dwordx4 v5, s[8:11], s28 offen lds
    s_add_u32 m0, s30, s34
    s_nop 0
    buffer_load_dwordx4 v6, s[12:15], s29 offen lds
    s_cmp_ge_u32 s24, 4
    s_cbranch_scc1 w2_4
    s_add_u32 m0, m0, 8192
    s_nop 0
    buffer_load_dwordx4 v7, s[12:15], s29 offen lds
w2_4:
    s_add_u32 s28, s28, 64
    s_add_u32 s29, s29, 294912
    s_add_u32 s38, s38, 1
    s_cmp_ge_u32 s38, 18
    s_cselect_b32 s28, 0x40000000, s28
    s_cselect_b32 s29, 0x40000000, s29
    s_add_u32 s30, s30, 30720
    s_cmp_eq_u32 s30, 153600
    s_cselect_b32 s30, 0, s30
    v_and_b32 v64, 15, v1
    v_lshrrev_b32 v65, 5, v1
    v_lshrrev_b32 v66, 2, v64
    v_lshl_add_u32 v66, v65, 3, v66
    v_bfe_u32 v67, v1, 4, 1
    v_lshlrev_b32 v67, 5, v67
    v_and_b32 v68, 3, v64
    v_lshl_add_u32 v67, v68, 3, v67
    v_mul_u32_u24 v68, 64, v66
    v_add_u32 v19, v68, v67
    v_add_u32 v19, 28672, v19
    v_mul_u32_u24 v66, 384, v66
    v_add_u32 v66, v66, v67
    v_bfe_u32 v67, v1, 3, 1
    v_xor_b32 v67, s39, v67
    v_lshl_add_u32 v66, v67, 6, v66
    v_add_u32 v18, 16384, v66
    v_and_b32 v64, 31, v1
    v_bfe_u32 v65, v1, 2, 2
    v_lshrrev_b32 v66, 5, v1
    v_add_u32 v66, 0, v66
    v_xor_b32 v65, v65, v66
    v_lshlrev_b32 v64, 6, v64
    v_lshl_add_u32 v64, v65, 4, v64
    s_lshr_b32 s4, s24, 1
    s_lshl_b32 s4, s4, 12
    v_add_u32 v16, s4, v64
    v_and_b32 v64, 31, v1
    v_bfe_u32 v65, v1, 2, 2
    v_lshrrev_b32 v66, 5, v1
    v_add_u32 v66, 2, v66
    v_xor_b32 v65, v65, v66
    v_lshlrev_b32 v64, 6, v64
    v_lshl_add_u32 v64, v65, 4, v64
    s_lshr_b32 s4, s24, 1
    s_lshl_b32 s4, s4, 12
    v_add_u32 v17, s4, v64
    s_waitcnt vmcnt(9)
    v_lshlrev_b32 v128, 16, v72
    v_and_b32 v129, 0xffff0000, v72
    v_lshlrev_b32 v144, 16, v72
    v_and_b32 v145, 0xffff0000, v72
    v_lshlrev_b32 v130, 16, v73
    v_and_b32 v131, 0xffff0000, v73
    v_lshlrev_b32 v146, 16, v73
    v_and_b32 v147, 0xffff0000, v73
    v_lshlrev_b32 v132, 16, v74
    v_and_b32 v133, 0xffff0000, v74
    v_lshlrev_b32 v148, 16, v74
    v_and_b32 v149, 0xffff0000, v74
    v_lshlrev_b32 v134, 16, v75
    v_and_b32 v135, 0xffff0000, v75
    v_lshlrev_b32 v150, 16, v75
    v_and_b32 v151, 0xffff0000, v75
    v_lshlrev_b32 v136, 16, v76
    v_and_b32 v137, 0xffff0000, v76
    v_lshlrev_b32 v152, 16, v76
    v_and_b32 v153, 0xffff0000, v76
    v_lshlrev_b32 v138, 16, v77
    v_and_b32 v139, 0xffff0000, v77
    v_lshlrev_b32 v154, 16, v77
    v_and_b32 v155, 0xffff0000, v77
    v_lshlrev_b32 v140, 16, v78
    v_and_b32 v141, 0xffff0000, v78
    v_lshlrev_b32 v156, 16, v78
    v_and_b32 v157, 0xffff0000, v78
    v_lshlrev_b32 v142, 16, v79
    v_and_b32 v143, 0xffff0000, v79
    v_lshlrev_b32 v158, 16, v79
    v_and_b32 v159, 0xffff0000, v79
    v_lshlrev_b32 v160, 16, v80
    v_and_b32 v161, 0xffff0000, v80
    v_lshlrev_b32 v176, 16, v80
    v_and_b32 v177, 0xffff0000, v80
    v_lshlrev_b32 v162, 16, v81
    v_and_b32 v163, 0xffff0000, v81
    v_lshlrev_b32 v178, 16, v81
    v_and_b32 v179, 0xffff0000, v81
    v_lshlrev_b32 v164, 16, v82
    v_and_b32 v165, 0xffff0000, v82
    v_lshlrev_b32 v180, 16, v82
    v_and_b32 v181, 0xffff0000, v82
    v_lshlrev_b32 v166, 16, v83
    v_and_b32 v167, 0xffff0000, v83
    v_lshlrev_b32 v182, 16, v83
    v_and_b32 v183, 0xffff0000, v83
    v_lshlrev_b32 v168, 16, v84
    v_and_b32 v169, 0xffff0000, v84
    v_lshlrev_b32 v184, 16, v84
    v_and_b32 v185, 0xffff0000, v84
    v_lshlrev_b32 v170, 16, v85
    v_and_b32 v171, 0xffff0000, v85
    v_lshlrev_b32 v186, 16, v85
    v_and_b32 v187, 0xffff0000, v85
    v_lshlrev_b32 v172, 16, v86
    v_and_b32 v173, 0xffff0000, v86
    v_lshlrev_b32 v188, 16, v86
    v_and_b32 v189, 0xffff0000, v86
    v_lshlrev_b32 v174, 16, v87
    v_and_b32 v175, 0xffff0000, v87
    v_lshlrev_b32 v190, 16, v87
    v_and_b32 v191, 0xffff0000, v87
    v_lshlrev_b32 v192, 16, v88
    v_and_b32 v193, 0xffff0000, v88
    v_lshlrev_b32 v208, 16, v88
    v_and_b32 v209, 0xffff0000, v88
    v_lshlrev_b32 v194, 16, v89
    v_and_b32 v195, 0xffff0000, v89
    v_lshlrev_b32 v210, 16, v89
    v_and_b32 v211, 0xffff0000, v89
    v_lshlrev_b32 v196, 16, v90
    v_and_b32 v197, 0xffff0000, v90
    v_lshlrev_b32 v212, 16, v90
    v_and_b32 v213, 0xffff0000, v90
    v_lshlrev_b32 v198, 16, v91
    v_and_b32 v199, 0xffff0000, v91
    v_lshlrev_b32 v214, 16, v91
    v_and_b32 v215, 0xffff0000, v91
    v_lshlrev_b32 v200, 16, v92
    v_and_b32 v201, 0xffff0000, v92
    v_lshlrev_b32 v216, 16, v92
    v_and_b32 v217, 0xffff0000, v92
    v_lshlrev_b32 v202, 16, v93
    v_and_b32 v203, 0xffff0000, v93
    v_lshlrev_b32 v218, 16, v93
    v_and_b32 v219, 0xffff0000, v93
    v_lshlrev_b32 v204, 16, v94
    v_and_b32 v205, 0xffff0000, v94
    v_lshlrev_b32 v220, 16, v94
    v_and_b32 v221, 0xffff0000, v94
    v_lshlrev_b32 v206, 16, v95
    v_and_b32 v207, 0xffff0000, v95
    v_lshlrev_b32 v222, 16, v95
    v_and_b32 v223, 0xffff0000, v95
    s_barrier
    s_mov_b32 s40, 0
    v_add_u32 v10, s40, v16
    v_add_u32 v11, s40, v17
    v_add_u32 v12, s40, v18
    ds_read_b128 v[24:27], v10 offset:0
    ds_read_b128 v[28:31], v10 offset:2048
    ds_read_b64_tr_b16 v[32:33], v12 offset:0
    ds_read_b64_tr_b16 v[34:35], v12 offset:1536
    ds_read_b64_tr_b16 v[36:37], v12 offset:128
    ds_read_b64_tr_b16 v[38:39], v12 offset:1664
    ds_read_b64_tr_b16 v[40:41], v12 offset:256
    ds_read_b64_tr_b16 v[42:43], v12 offset:1792
    s_mov_b32 s27, 0
k1loop_5:
    s_waitcnt lgkmcnt(0)
    ds_read_b128 v[48:51], v11 offset:0
    ds_read_b128 v[52:55], v11 offset:2048
    ds_read_b64_tr_b16 v[56:57], v12 offset:6144
    ds_read_b64_tr_b16 v[58:59], v12 offset:7680
    v_mfma_f32_32x32x16_bf16 v[128:143], v[32:35], v[24:27], v[128:143]
    ds_read_b64_tr_b16 v[60:61], v12 offset:6272
    ds_read_b64_tr_b16 v[62:63], v12 offset:7808
    s_add_u32 m0, s30, s33
    s_nop 0
    buffer_load_dwordx4 v4, s[8:11], s28 offen lds
    v_mfma_f32_32x32x16_bf16 v[144:159], v[32:35], v[28:31], v[144:159]
    ds_read_b64_tr_b16 v[64:65], v12 offset:6400
    ds_read_b64_tr_b16 v[66:67], v12 offset:7936
    s_add_u32 m0, m0, 1024
    s_nop 0
    buffer_load_dwordx4 v5, s[8:11], s28 offen lds
    v_mfma_f32_32x32x16_bf16 v[160:175], v[36:39], v[24:27], v[160:175]
    s_add_u32 m0, s30, s34
    s_nop 0
    buffer_load_dwordx4 v6, s[12:15], s29 offen lds
    v_mfma_f32_32x32x16_bf16 v[176:191], v[36:39], v[28:31], v[176:191]
    s_cmp_ge_u32 s24, 4
    s_cbranch_scc1 w2_6
    s_add_u32 m0, m0, 8192
    s_nop 0
    buffer_load_dwordx4 v7, s[12:15], s29 offen lds
w2_6:
    s_add_u32 s28, s28, 64
    s_add_u32 s29, s29, 294912
    s_add_u32 s38, s38, 1
    s_cmp_ge_u32 s38, 18
    s_cselect_b32 s28, 0x40000000, s28
    s_cselect_b32 s29, 0x40000000, s29
    s_add_u32 s30, s30, 30720
    s_cmp_eq_u32 s30, 153600
    s_cselect_b32 s30, 0, s30
    v_mfma_f32_32x32x16_bf16 v[192:207], v[40:43], v[24:27], v[192:207]
    v_mfma_f32_32x32x16_bf16 v[208:223], v[40:43], v[28:31], v[208:223]
    s_waitcnt lgkmcnt(0)
    s_waitcnt vmcnt(9)
    s_barrier
    s_add_u32 s40, s40, 30720
    s_cmp_eq_u32 s40, 153600
    s_cselect_b32 s40, 0, s40
    v_add_u32 v10, s40, v16
    v_add_u32 v11, s40, v17
    v_add_u32 v12, s40, v18
    ds_read_b128 v[24:27], v10 offset:0
    ds_read_b128 v[28:31], v10 offset:2048
    ds_read_b64_tr_b16 v[32:33], v12 offset:0
    ds_read_b64_tr_b16 v[34:35], v12 offset:1536
    v_mfma_f32_32x32x16_bf16 v[128:143], v[56:59], v[48:51], v[128:143]
    ds_read_b64_tr_b16 v[36:37], v12 offset:128
    ds_read_b64_tr_b16 v[38:39], v12 offset:1664
    v_mfma_f32_32x32x16_bf16 v[144:159], v[56:59], v[52:55], v[144:159]
    ds_read_b64_tr_b16 v[40:41], v12 offset:256
    ds_read_b64_tr_b16 v[42:43], v12 offset:1792
    v_mfma_f32_32x32x16_bf16 v[160:175], v[60:63], v[48:51], v[160:175]
    v_mfma_f32_32x32x16_bf16 v[176:191], v[60:63], v[52:55], v[176:191]
    v_mfma_f32_32x32x16_bf16 v[192:207], v[64:67], v[48:51], v[192:207]
    v_mfma_f32_32x32x16_bf16 v[208:223], v[64:67], v[52:55], v[208:223]
    s_add_u32 s27, s27, 1
    s_cmp_lt_u32 s27, 18
    s_cbranch_scc1 k1loop_5
    s_waitcnt lgkmcnt(0)
    s_nop 15
    s_nop 7
    v_max_f32 v96, 0, v128
    v_max_f32 v97, 0, v129
    v_max_f32 v98, 0, v130
    v_max_f32 v99, 0, v131
    v_max_f32 v100, 0, v132
    v_max_f32 v101, 0, v133
    v_max_f32 v102, 0, v134
    v_max_f32 v103, 0, v135
    v_max_f32 v104, 0, v136
    v_max_f32 v105, 0, v137
    v_max_f32 v106, 0, v138
    v_max_f32 v107, 0, v139
    v_max_f32 v108, 0, v140
    v_max_f32 v109, 0, v141
    v_max_f32 v110, 0, v142
    v_max_f32 v111, 0, v143
    v_pk_mul_f32 v[128:129], v[96:97], v[96:97]
    v_pk_mul_f32 v[130:131], v[98:99], v[98:99]
    v_pk_mul_f32 v[132:133], v[100:101], v[100:101]
    v_pk_mul_f32 v[134:135], v[102:103], v[102:103]
    v_pk_mul_f32 v[136:137], v[104:105], v[104:105]
    v_pk_mul_f32 v[138:139], v[106:107], v[106:107]
    v_pk_mul_f32 v[140:141], v[108:109], v[108:109]
    v_pk_mul_f32 v[142:143], v[110:111], v[110:111]
    v_cvt_pk_bf16_f32 v64, v128, v129
    v_cvt_pk_bf16_f32 v65, v130, v131
    v_cvt_pk_bf16_f32 v66, v132, v133
    v_cvt_pk_bf16_f32 v67, v134, v135
    v_cvt_pk_bf16_f32 v68, v136, v137
    v_cvt_pk_bf16_f32 v69, v138, v139
    v_cvt_pk_bf16_f32 v70, v140, v141
    v_cvt_pk_bf16_f32 v71, v142, v143
    s_nop 1
    v_permlane32_swap_b32 v64, v66
    v_permlane32_swap_b32 v65, v67
    v_permlane32_swap_b32 v68, v70
    v_permlane32_swap_b32 v69, v71
    s_add_u32 s4, s41, 0
    s_mul_i32 s4, s4, 294912
    s_mul_i32 s5, s26, 12288
    s_add_u32 s4, s4, s5
    s_lshl_b32 s5, s39, 11
    s_add_u32 s4, s4, s5
    s_add_u32 s4, s4, 0
    buffer_store_dwordx4 v[64:67], v15, s[16:19], s4 offen sc0 sc1
    buffer_store_dwordx4 v[68:71], v15, s[16:19], s4 offen offset:1024 sc0 sc1
    s_nop 1
    v_max_f32 v96, 0, v144
    v_max_f32 v97, 0, v145
    v_max_f32 v98, 0, v146
    v_max_f32 v99, 0, v147
    v_max_f32 v100, 0, v148
    v_max_f32 v101, 0, v149
    v_max_f32 v102, 0, v150
    v_max_f32 v103, 0, v151
    v_max_f32 v104, 0, v152
    v_max_f32 v105, 0, v153
    v_max_f32 v106, 0, v154
    v_max_f32 v107, 0, v155
    v_max_f32 v108, 0, v156
    v_max_f32 v109, 0, v157
    v_max_f32 v110, 0, v158
    v_max_f32 v111, 0, v159
    v_pk_mul_f32 v[144:145], v[96:97], v[96:97]
    v_pk_mul_f32 v[146:147], v[98:99], v[98:99]
    v_pk_mul_f32 v[148:149], v[100:101], v[100:101]
    v_pk_mul_f32 v[150:151], v[102:103], v[102:103]
    v_pk_mul_f32 v[152:153], v[104:105], v[104:105]
    v_pk_mul_f32 v[154:155], v[106:107], v[106:107]
    v_pk_mul_f32 v[156:157], v[108:109], v[108:109]
    v_pk_mul_f32 v[158:159], v[110:111], v[110:111]
    v_cvt_pk_bf16_f32 v72, v144, v145
    v_cvt_pk_bf16_f32 v73, v146, v147
    v_cvt_pk_bf16_f32 v74, v148, v149
    v_cvt_pk_bf16_f32 v75, v150, v151
    v_cvt_pk_bf16_f32 v76, v152, v153
    v_cvt_pk_bf16_f32 v77, v154, v155
    v_cvt_pk_bf16_f32 v78, v156, v157
    v_cvt_pk_bf16_f32 v79, v158, v159
    s_nop 1
    v_permlane32_swap_b32 v72, v74
    v_permlane32_swap_b32 v73, v75
    v_permlane32_swap_b32 v76, v78
    v_permlane32_swap_b32 v77, v79
    s_add_u32 s4, s41, 1
    s_mul_i32 s4, s4, 294912
    s_mul_i32 s5, s26, 12288
    s_add_u32 s4, s4, s5
    s_lshl_b32 s5, s39, 11
    s_add_u32 s4, s4, s5
    s_add_u32 s4, s4, 0
    buffer_store_dwordx4 v[72:75], v15, s[16:19], s4 offen sc0 sc1
    buffer_store_dwordx4 v[76:79], v15, s[16:19], s4 offen offset:1024 sc0 sc1
    s_nop 1
    v_max_f32 v96, 0, v160
    v_max_f32 v97, 0, v161
    v_max_f32 v98, 0, v162
    v_max_f32 v99, 0, v163
    v_max_f32 v100, 0, v164
    v_max_f32 v101, 0, v165
    v_max_f32 v102, 0, v166
    v_max_f32 v103, 0, v167
    v_max_f32 v104, 0, v168
    v_max_f32 v105, 0, v169
    v_max_f32 v106, 0, v170
    v_max_f32 v107, 0, v171
    v_max_f32 v108, 0, v172
    v_max_f32 v109, 0, v173
    v_max_f32 v110, 0, v174
    v_max_f32 v111, 0, v175
    v_pk_mul_f32 v[160:161], v[96:97], v[96:97]
    v_pk_mul_f32 v[162:163], v[98:99], v[98:99]
    v_pk_mul_f32 v[164:165], v[100:101], v[100:101]
    v_pk_mul_f32 v[166:167], v[102:103], v[102:103]
    v_pk_mul_f32 v[168:169], v[104:105], v[104:105]
    v_pk_mul_f32 v[170:171], v[106:107], v[106:107]
    v_pk_mul_f32 v[172:173], v[108:109], v[108:109]
    v_pk_mul_f32 v[174:175], v[110:111], v[110:111]
    v_cvt_pk_bf16_f32 v80, v160, v161
    v_cvt_pk_bf16_f32 v81, v162, v163
    v_cvt_pk_bf16_f32 v82, v164, v165
    v_cvt_pk_bf16_f32 v83, v166, v167
    v_cvt_pk_bf16_f32 v84, v168, v169
    v_cvt_pk_bf16_f32 v85, v170, v171
    v_cvt_pk_bf16_f32 v86, v172, v173
    v_cvt_pk_bf16_f32 v87, v174, v175
    s_nop 1
    v_permlane32_swap_b32 v80, v82
    v_permlane32_swap_b32 v81, v83
    v_permlane32_swap_b32 v84, v86
    v_permlane32_swap_b32 v85, v87
    s_add_u32 s4, s41, 0
    s_mul_i32 s4, s4, 294912
    s_mul_i32 s5, s26, 12288
    s_add_u32 s4, s4, s5
    s_lshl_b32 s5, s39, 11
    s_add_u32 s4, s4, s5
    s_add_u32 s4, s4, 4096
    buffer_store_dwordx4 v[80:83], v15, s[16:19], s4 offen sc0 sc1
    buffer_store_dwordx4 v[84:87], v15, s[16:19], s4 offen offset:1024 sc0 sc1
    s_nop 1
    v_max_f32 v96, 0, v176
    v_max_f32 v97, 0, v177
    v_max_f32 v98, 0, v178
    v_max_f32 v99, 0, v179
    v_max_f32 v100, 0, v180
    v_max_f32 v101, 0, v181
    v_max_f32 v102, 0, v182
    v_max_f32 v103, 0, v183
    v_max_f32 v104, 0, v184
    v_max_f32 v105, 0, v185
    v_max_f32 v106, 0, v186
    v_max_f32 v107, 0, v187
    v_max_f32 v108, 0, v188
    v_max_f32 v109, 0, v189
    v_max_f32 v110, 0, v190
    v_max_f32 v111, 0, v191
    v_pk_mul_f32 v[176:177], v[96:97], v[96:97]
    v_pk_mul_f32 v[178:179], v[98:99], v[98:99]
    v_pk_mul_f32 v[180:181], v[100:101], v[100:101]
    v_pk_mul_f32 v[182:183], v[102:103], v[102:103]
    v_pk_mul_f32 v[184:185], v[104:105], v[104:105]
    v_pk_mul_f32 v[186:187], v[106:107], v[106:107]
    v_pk_mul_f32 v[188:189], v[108:109], v[108:109]
    v_pk_mul_f32 v[190:191], v[110:111], v[110:111]
    v_cvt_pk_bf16_f32 v88, v176, v177
    v_cvt_pk_bf16_f32 v89, v178, v179
    v_cvt_pk_bf16_f32 v90, v180, v181
    v_cvt_pk_bf16_f32 v91, v182, v183
    v_cvt_pk_bf16_f32 v92, v184, v185
    v_cvt_pk_bf16_f32 v93, v186, v187
    v_cvt_pk_bf16_f32 v94, v188, v189
    v_cvt_pk_bf16_f32 v95, v190, v191
    s_nop 1
    v_permlane32_swap_b32 v88, v90
    v_permlane32_swap_b32 v89, v91
    v_permlane32_swap_b32 v92, v94
    v_permlane32_swap_b32 v93, v95
    s_add_u32 s4, s41, 1
    s_mul_i32 s4, s4, 294912
    s_mul_i32 s5, s26, 12288
    s_add_u32 s4, s4, s5
    s_lshl_b32 s5, s39, 11
    s_add_u32 s4, s4, s5
    s_add_u32 s4, s4, 4096
    buffer_store_dwordx4 v[88:91], v15, s[16:19], s4 offen sc0 sc1
    buffer_store_dwordx4 v[92:95], v15, s[16:19], s4 offen offset:1024 sc0 sc1
    s_nop 1
    v_max_f32 v96, 0, v192
    v_max_f32 v97, 0, v193
    v_max_f32 v98, 0, v194
    v_max_f32 v99, 0, v195
    v_max_f32 v100, 0, v196
    v_max_f32 v101, 0, v197
    v_max_f32 v102, 0, v198
    v_max_f32 v103, 0, v199
    v_max_f32 v104, 0, v200
    v_max_f32 v105, 0, v201
    v_max_f32 v106, 0, v202
    v_max_f32 v107, 0, v203
    v_max_f32 v108, 0, v204
    v_max_f32 v109, 0, v205
    v_max_f32 v110, 0, v206
    v_max_f32 v111, 0, v207
    v_pk_mul_f32 v[192:193], v[96:97], v[96:97]
    v_pk_mul_f32 v[194:195], v[98:99], v[98:99]
    v_pk_mul_f32 v[196:197], v[100:101], v[100:101]
    v_pk_mul_f32 v[198:199], v[102:103], v[102:103]
    v_pk_mul_f32 v[200:201], v[104:105], v[104:105]
    v_pk_mul_f32 v[202:203], v[106:107], v[106:107]
    v_pk_mul_f32 v[204:205], v[108:109], v[108:109]
    v_pk_mul_f32 v[206:207], v[110:111], v[110:111]
    v_cvt_pk_bf16_f32 v64, v192, v193
    v_cvt_pk_bf16_f32 v65, v194, v195
    v_cvt_pk_bf16_f32 v66, v196, v197
    v_cvt_pk_bf16_f32 v67, v198, v199
    v_cvt_pk_bf16_f32 v68, v200, v201
    v_cvt_pk_bf16_f32 v69, v202, v203
    v_cvt_pk_bf16_f32 v70, v204, v205
    v_cvt_pk_bf16_f32 v71, v206, v207
    s_nop 1
    v_permlane32_swap_b32 v64, v66
    v_permlane32_swap_b32 v65, v67
    v_permlane32_swap_b32 v68, v70
    v_permlane32_swap_b32 v69, v71
    s_add_u32 s4, s41, 0
    s_mul_i32 s4, s4, 294912
    s_mul_i32 s5, s26, 12288
    s_add_u32 s4, s4, s5
    s_lshl_b32 s5, s39, 11
    s_add_u32 s4, s4, s5
    s_add_u32 s4, s4, 8192
    buffer_store_dwordx4 v[64:67], v15, s[16:19], s4 offen sc0 sc1
    buffer_store_dwordx4 v[68:71], v15, s[16:19], s4 offen offset:1024 sc0 sc1
    s_nop 1
    v_max_f32 v96, 0, v208
    v_max_f32 v97, 0, v209
    v_max_f32 v98, 0, v210
    v_max_f32 v99, 0, v211
    v_max_f32 v100, 0, v212
    v_max_f32 v101, 0, v213
    v_max_f32 v102, 0, v214
    v_max_f32 v103, 0, v215
    v_max_f32 v104, 0, v216
    v_max_f32 v105, 0, v217
    v_max_f32 v106, 0, v218
    v_max_f32 v107, 0, v219
    v_max_f32 v108, 0, v220
    v_max_f32 v109, 0, v221
    v_max_f32 v110, 0, v222
    v_max_f32 v111, 0, v223
    v_pk_mul_f32 v[208:209], v[96:97], v[96:97]
    v_pk_mul_f32 v[210:211], v[98:99], v[98:99]
    v_pk_mul_f32 v[212:213], v[100:101], v[100:101]
    v_pk_mul_f32 v[214:215], v[102:103], v[102:103]
    v_pk_mul_f32 v[216:217], v[104:105], v[104:105]
    v_pk_mul_f32 v[218:219], v[106:107], v[106:107]
    v_pk_mul_f32 v[220:221], v[108:109], v[108:109]
    v_pk_mul_f32 v[222:223], v[110:111], v[110:111]
    v_cvt_pk_bf16_f32 v72, v208, v209
    v_cvt_pk_bf16_f32 v73, v210, v211
    v_cvt_pk_bf16_f32 v74, v212, v213
    v_cvt_pk_bf16_f32 v75, v214, v215
    v_cvt_pk_bf16_f32 v76, v216, v217
    v_cvt_pk_bf16_f32 v77, v218, v219
    v_cvt_pk_bf16_f32 v78, v220, v221
    v_cvt_pk_bf16_f32 v79, v222, v223
    s_nop 1
    v_permlane32_swap_b32 v72, v74
    v_permlane32_swap_b32 v73, v75
    v_permlane32_swap_b32 v76, v78
    v_permlane32_swap_b32 v77, v79
    s_add_u32 s4, s41, 1
    s_mul_i32 s4, s4, 294912
    s_mul_i32 s5, s26, 12288
    s_add_u32 s4, s4, s5
    s_lshl_b32 s5, s39, 11
    s_add_u32 s4, s4, s5
    s_add_u32 s4, s4, 8192
    buffer_store_dwordx4 v[72:75], v15, s[16:19], s4 offen sc0 sc1
    buffer_store_dwordx4 v[76:79], v15, s[16:19], s4 offen offset:1024 sc0 sc1
    s_nop 1
    s_endpgm
k1_qkl:
    s_add_u32 s4, s24, 0
    s_lshl_b32 s4, s4, 6
    v_add_u32 v64, s4, v1
    s_mov_b32 s5, 2731
    v_mul_lo_u32 v65, v64, s5
    v_lshrrev_b32 v65, 16, v65
    v_mul_u32_u24 v66, 24, v65
    v_sub_u32 v66, v64, v66
    v_lshlrev_b32 v67, 1, v65
    v_and_b32 v67, 4, v67
    v_xor_b32 v66, v66, v67
    v_lshrrev_b32 v67, 1, v66
    v_mul_u32_u24 v67, 36, v67
    v_and_b32 v66, 1, v66
    v_lshl_add_u32 v66, v66, 4, v67
    v_mul_u32_u24 v65, 3456, v65
    s_mul_i32 s4, s31, 72
    v_add3_u32 v6, v65, v66, s4
    s_add_u32 s4, s24, 8
    s_lshl_b32 s4, s4, 6
    v_add_u32 v64, s4, v1
    s_mov_b32 s5, 2731
    v_mul_lo_u32 v65, v64, s5
    v_lshrrev_b32 v65, 16, v65
    v_mul_u32_u24 v66, 24, v65
    v_sub_u32 v66, v64, v66
    v_lshlrev_b32 v67, 1, v65
    v_and_b32 v67, 4, v67
    v_xor_b32 v66, v66, v67
    v_lshrrev_b32 v67, 1, v66
    v_mul_u32_u24 v67, 36, v67
    v_and_b32 v66, 1, v66
    v_lshl_add_u32 v66, v66, 4, v67
    v_mul_u32_u24 v65, 3456, v65
    s_mul_i32 s4, s31, 72
    v_add3_u32 v7, v65, v66, s4
    s_lshl_b32 s4, s24, 2
    v_lshrrev_b32 v64, 4, v1
    v_add_u32 v64, s4, v64
    v_mul_u32_u24 v64, 3456, v64
    v_and_b32 v65, 15, v1
    v_mul_u32_u24 v65, 36, v65
    s_mul_i32 s4, s36, 576
    s_add_u32 s4, s4, 32
    v_add3_u32 v8, v64, v65, s4
    s_lshl_b32 s33, s24, 11
    s_lshl_b32 s34, s24, 10
    s_add_u32 s34, s34, 16384
    s_lshl_b32 s37, s24, 8
    s_add_u32 s37, s37, 28672
    s_mov_b32 s28, 0
    s_mov_b32 s29, 0
    s_mov_b32 s30, 0
    s_mov_b32 s38, 0
    s_add_u32 m0, s30, s33
    s_nop 0
    buffer_load_dwordx4 v4, s[8:11], s28 offen lds
    s_add_u32 m0, m0, 1024
    s_nop 0
    buffer_load_dwordx4 v5, s[8:11], s28 offen lds
    s_add_u32 m0, s30, s34
    s_nop 0
    buffer_load_dwordx4 v6, s[12:15], s29 offen lds
    s_cmp_ge_u32 s24, 4
    s_cbranch_scc1 w2_7
    s_add_u32 m0, m0, 8192
    s_nop 0
    buffer_load_dwordx4 v7, s[12:15], s29 offen lds
w2_7:
    s_add_u32 m0, s30, s37
    s_nop 0
    buffer_load_dword v8, s[12:15], s29 offen lds
    s_add_u32 s28, s28, 64
    s_add_u32 s29, s29, 110592
    s_add_u32 s38, s38, 1
    s_cmp_ge_u32 s38, 18
    s_cselect_b32 s28, 0x40000000, s28
    s_cselect_b32 s29, 0x40000000, s29
    s_add_u32 s30, s30, 30720
    s_cmp_eq_u32 s30, 153600
    s_cselect_b32 s30, 0, s30
    s_add_u32 m0, s30, s33
    s_nop 0
    buffer_load_dwordx4 v4, s[8:11], s28 offen lds
    s_add_u32 m0, m0, 1024
    s_nop 0
    buffer_load_dwordx4 v5, s[8:11], s28 offen lds
    s_add_u32 m0, s30, s34
    s_nop 0
    buffer_load_dwordx4 v6, s[12:15], s29 offen lds
    s_cmp_ge_u32 s24, 4
    s_cbranch_scc1 w2_8
    s_add_u32 m0, m0, 8192
    s_nop 0
    buffer_load_dwordx4 v7, s[12:15], s29 offen lds
w2_8:
    s_add_u32 m0, s30, s37
    s_nop 0
    buffer_load_dword v8, s[12:15], s29 offen lds
    s_add_u32 s28, s28, 64
    s_add_u32 s29, s29, 110592
    s_add_u32 s38, s38, 1
    s_cmp_ge_u32 s38, 18
    s_cselect_b32 s28, 0x40000000, s28
    s_cselect_b32 s29, 0x40000000, s29
    s_add_u32 s30, s30, 30720
    s_cmp_eq_u32 s30, 153600
    s_cselect_b32 s30, 0, s30
    s_add_u32 m0, s30, s33
    s_nop 0
    buffer_load_dwordx4 v4, s[8:11], s28 offen lds
    s_add_u32 m0, m0, 1024
    s_nop 0
    buffer_load_dwordx4 v5, s[8:11], s28 offen lds
    s_add_u32 m0, s30, s34
    s_nop 0
    buffer_load_dwordx4 v6, s[12:15], s29 offen lds
    s_cmp_ge_u32 s24, 4
    s_cbranch_scc1 w2_9
    s_add_u32 m0, m0, 8192
    s_nop 0
    buffer_load_dwordx4 v7, s[12:15], s29 offen lds
w2_9:
    s_add_u32 m0, s30, s37
    s_nop 0
    buffer_load_dword v8, s[12:15], s29 offen lds
    s_add_u32 s28, s28, 64
    s_add_u32 s29, s29, 110592
    s_add_u32 s38, s38, 1
    s_cmp_ge_u32 s38, 18
    s_cselect_b32 s28, 0x40000000, s28
    s_cselect_b32 s29, 0x40000000, s29
    s_add_u32 s30, s30, 30720
    s_cmp_eq_u32 s30, 153600
    s_cselect_b32 s30, 0, s30
    s_add_u32 m0, s30, s33
    s_nop 0
    buffer_load_dwordx4 v4, s[8:11], s28 offen lds
    s_add_u32 m0, m0, 1024
    s_nop 0
    buffer_load_dwordx4 v5, s[8:11], s28 offen lds
    s_add_u32 m0, s30, s34
    s_nop 0
    buffer_load_dwordx4 v6, s[12:15], s29 offen lds
    s_cmp_ge_u32 s24, 4
    s_cbranch_scc1 w2_10
    s_add_u32 m0, m0, 8192
    s_nop 0
    buffer_load_dwordx4 v7, s[12:15], s29 offen lds
w2_10:
    s_add_u32 m0, s30, s37
    s_nop 0
    buffer_load_dword v8, s[12:15], s29 offen lds
    s_add_u32 s28, s28, 64
    s_add_u32 s29, s29, 110592
    s_add_u32 s38, s38, 1
    s_cmp_ge_u32 s38, 18
    s_cselect_b32 s28, 0x40000000, s28
    s_cselect_b32 s29, 0x40000000, s29
    s_add_u32 s30, s30, 30720
    s_cmp_eq_u32 s30, 153600
    s_cselect_b32 s30, 0, s30
    s_lshr_b32 s4, s2, 3
    s_mul_i32 s4, s4, 486
    v_add_u32 v64, s4, v0
    v_lshlrev_b32 v64, 7, v64
    v_mov_b32 v65, 0x7f000000
    v_cmp_gt_u32 vcc, 486, v0
    v_cndmask_b32 v64, v65, v64, vcc
    buffer_load_dword v97, v64, s[12:15], 0 offen
    v_and_b32 v64, 15, v1
    v_lshrrev_b32 v65, 5, v1
    v_lshrrev_b32 v66, 2, v64
    v_lshl_add_u32 v66, v65, 3, v66
    v_bfe_u32 v67, v1, 4, 1
    v_lshlrev_b32 v67, 5, v67
    v_and_b32 v68, 3, v64
    v_lshl_add_u32 v67, v68, 3, v67
    v_mul_u32_u24 v68, 64, v66
    v_add_u32 v19, v68, v67
    v_add_u32 v19, 28672, v19
    v_mul_u32_u24 v66, 384, v66
    v_add_u32 v66, v66, v67
    v_bfe_u32 v67, v1, 3, 1
    v_xor_b32 v67, s39, v67
    v_lshl_add_u32 v66, v67, 6, v66
    v_add_u32 v18, 16384, v66
    v_and_b32 v64, 31, v1
    v_bfe_u32 v65, v1, 2, 2
    v_lshrrev_b32 v66, 5, v1
    v_add_u32 v66, 0, v66
    v_xor_b32 v65, v65, v66
    v_lshlrev_b32 v64, 6, v64
    v_lshl_add_u32 v64, v65, 4, v64
    s_lshr_b32 s4, s24, 1
    s_lshl_b32 s4, s4, 12
    v_add_u32 v16, s4, v64
    v_and_b32 v64, 31, v1
    v_bfe_u32 v65, v1, 2, 2
    v_lshrrev_b32 v66, 5, v1
    v_add_u32 v66, 2, v66
    v_xor_b32 v65, v65, v66
    v_lshlrev_b32 v64, 6, v64
    v_lshl_add_u32 v64, v65, 4, v64
    s_lshr_b32 s4, s24, 1
    s_lshl_b32 s4, s4, 12
    v_add_u32 v17, s4, v64
    v_mov_b32 v128, 0
    v_mov_b32 v129, 0
    v_mov_b32 v130, 0
    v_mov_b32 v131, 0
    v_mov_b32 v132, 0
    v_mov_b32 v133, 0
    v_mov_b32 v134, 0
    v_mov_b32 v135, 0
    v_mov_b32 v136, 0
    v_mov_b32 v137, 0
    v_mov_b32 v138, 0
    v_mov_b32 v139, 0
    v_mov_b32 v140, 0
    v_mov_b32 v141, 0
    v_mov_b32 v142, 0
    v_mov_b32 v143, 0
    v_mov_b32 v144, 0
    v_mov_b32 v145, 0
    v_mov_b32 v146, 0
    v_mov_b32 v147, 0
    v_mov_b32 v148, 0
    v_mov_b32 v149, 0
    v_mov_b32 v150, 0
    v_mov_b32 v151, 0
    v_mov_b32 v152, 0
    v_mov_b32 v153, 0
    v_mov_b32 v154, 0
    v_mov_b32 v155, 0
    v_mov_b32 v156, 0
    v_mov_b32 v157, 0
    v_mov_b32 v158, 0
    v_mov_b32 v159, 0
    v_mov_b32 v160, 0
    v_mov_b32 v161, 0
    v_mov_b32 v162, 0
    v_mov_b32 v163, 0
    v_mov_b32 v164, 0
    v_mov_b32 v165, 0
    v_mov_b32 v166, 0
    v_mov_b32 v167, 0
    v_mov_b32 v168, 0
    v_mov_b32 v169, 0
    v_mov_b32 v170, 0
    v_mov_b32 v171, 0
    v_mov_b32 v172, 0
    v_mov_b32 v173, 0
    v_mov_b32 v174, 0
    v_mov_b32 v175, 0
    v_mov_b32 v176, 0
    v_mov_b32 v177, 0
    v_mov_b32 v178, 0
    v_mov_b32 v179, 0
    v_mov_b32 v180, 0
    v_mov_b32 v181, 0
    v_mov_b32 v182, 0
    v_mov_b32 v183, 0
    v_mov_b32 v184, 0
    v_mov_b32 v185, 0
    v_mov_b32 v186, 0
    v_mov_b32 v187, 0
    v_mov_b32 v188, 0
    v_mov_b32 v189, 0
    v_mov_b32 v190, 0
    v_mov_b32 v191, 0
    v_mov_b32 v192, 0
    v_mov_b32 v193, 0
    v_mov_b32 v194, 0
    v_mov_b32 v195, 0
    v_mov_b32 v196, 0
    v_mov_b32 v197, 0
    v_mov_b32 v198, 0
    v_mov_b32 v199, 0
    v_mov_b32 v200, 0
    v_mov_b32 v201, 0
    v_mov_b32 v202, 0
    v_mov_b32 v203, 0
    v_mov_b32 v204, 0
    v_mov_b32 v205, 0
    v_mov_b32 v206, 0
    v_mov_b32 v207, 0
    v_mov_b32 v208, 0
    v_mov_b32 v209, 0
    v_mov_b32 v210, 0
    v_mov_b32 v211, 0
    v_mov_b32 v212, 0
    v_mov_b32 v213, 0
    v_mov_b32 v214, 0
    v_mov_b32 v215, 0
    v_mov_b32 v216, 0
    v_mov_b32 v217, 0
    v_mov_b32 v218, 0
    v_mov_b32 v219, 0
    v_mov_b32 v220, 0
    v_mov_b32 v221, 0
    v_mov_b32 v222, 0
    v_mov_b32 v223, 0
    v_mov_b32 v224, 0
    v_mov_b32 v225, 0
    v_mov_b32 v226, 0
    v_mov_b32 v227, 0
    v_mov_b32 v228, 0
    v_mov_b32 v229, 0
    v_mov_b32 v230, 0
    v_mov_b32 v231, 0
    v_mov_b32 v232, 0
    v_mov_b32 v233, 0
    v_mov_b32 v234, 0
    v_mov_b32 v235, 0
    v_mov_b32 v236, 0
    v_mov_b32 v237, 0
    v_mov_b32 v238, 0
    v_mov_b32 v239, 0
    s_waitcnt vmcnt(13)
    s_barrier
    s_mov_b32 s40, 0
    v_add_u32 v10, s40, v16
    v_add_u32 v11, s40, v17
    v_add_u32 v12, s40, v18
    v_add_u32 v13, s40, v19
    ds_read_b128 v[24:27], v10 offset:0
    ds_read_b128 v[28:31], v10 offset:2048
    ds_read_b64_tr_b16 v[32:33], v12 offset:0
    ds_read_b64_tr_b16 v[34:35], v12 offset:1536
    ds_read_b64_tr_b16 v[36:37], v12 offset:128
    ds_read_b64_tr_b16 v[38:39], v12 offset:1664
    ds_read_b64_tr_b16 v[40:41], v12 offset:256
    ds_read_b64_tr_b16 v[42:43], v12 offset:1792
    ds_read_b64_tr_b16 v[44:45], v13 offset:0
    ds_read_b64_tr_b16 v[46:47], v13 offset:256
    s_mov_b32 s27, 0
    s_cmp_eq_u32 s39, 0
    s_cbranch_scc1 lw0_11
k1loop_13:
    s_waitcnt lgkmcnt(0)
    ds_read_b128 v[48:51], v11 offset:0
    ds_read_b128 v[52:55], v11 offset:2048
    ds_read_b64_tr_b16 v[56:57], v12 offset:6144
    ds_read_b64_tr_b16 v[58:59], v12 offset:7680
    v_mfma_f32_32x32x16_bf16 v[128:143], v[32:35], v[24:27], v[128:143]
    ds_read_b64_tr_b16 v[60:61], v12 offset:6272
    ds_read_b64_tr_b16 v[62:63], v12 offset:7808
    s_add_u32 m0, s30, s33
    s_nop 0
    buffer_load_dwordx4 v4, s[8:11], s28 offen lds
    v_mfma_f32_32x32x16_bf16 v[144:159], v[32:35], v[28:31], v[144:159]
    ds_read_b64_tr_b16 v[64:65], v12 offset:6400
    ds_read_b64_tr_b16 v[66:67], v12 offset:7936
    s_add_u32 m0, m0, 1024
    s_nop 0
    buffer_load_dwordx4 v5, s[8:11], s28 offen lds
    v_mfma_f32_32x32x16_bf16 v[160:175], v[36:39], v[24:27], v[160:175]
    ds_read_b64_tr_b16 v[68:69], v13 offset:1024
    ds_read_b64_tr_b16 v[70:71], v13 offset:1280
    s_add_u32 m0, s30, s34
    s_nop 0
    buffer_load_dwordx4 v6, s[12:15], s29 offen lds
    v_mfma_f32_32x32x16_bf16 v[176:191], v[36:39], v[28:31], v[176:191]
    s_cmp_ge_u32 s24, 4
    s_cbranch_scc1 w2_14
    s_add_u32 m0, m0, 8192
    s_nop 0
    buffer_load_dwordx4 v7, s[12:15], s29 offen lds
w2_14:
    v_mfma_f32_32x32x16_bf16 v[192:207], v[40:43], v[24:27], v[192:207]
    s_add_u32 m0, s30, s37
    s_nop 0
    buffer_load_dword v8, s[12:15], s29 offen lds
    s_add_u32 s28, s28, 64
    s_add_u32 s29, s29, 110592
    s_add_u32 s38, s38, 1
    s_cmp_ge_u32 s38, 18
    s_cselect_b32 s28, 0x40000000, s28
    s_cselect_b32 s29, 0x40000000, s29
    s_add_u32 s30, s30, 30720
    s_cmp_eq_u32 s30, 153600
    s_cselect_b32 s30, 0, s30
    v_mfma_f32_32x32x16_bf16 v[208:223], v[40:43], v[28:31], v[208:223]
    v_mfma_f32_32x32x16_bf16 v[224:239], v[44:47], v[28:31], v[224:239]
    s_waitcnt lgkmcnt(0)
    s_waitcnt vmcnt(12)
    s_barrier
    s_add_u32 s40, s40, 30720
    s_cmp_eq_u32 s40, 153600
    s_cselect_b32 s40, 0, s40
    v_add_u32 v10, s40, v16
    v_add_u32 v11, s40, v17
    v_add_u32 v12, s40, v18
    v_add_u32 v13, s40, v19
    ds_read_b128 v[24:27], v10 offset:0
    ds_read_b128 v[28:31], v10 offset:2048
    ds_read_b64_tr_b16 v[32:33], v12 offset:0
    ds_read_b64_tr_b16 v[34:35], v12 offset:1536
    v_mfma_f32_32x32x16_bf16 v[128:143], v[56:59], v[48:51], v[128:143]
    ds_read_b64_tr_b16 v[36:37], v12 offset:128
    ds_read_b64_tr_b16 v[38:39], v12 offset:1664
    v_mfma_f32_32x32x16_bf16 v[144:159], v[56:59], v[52:55], v[144:159]
    ds_read_b64_tr_b16 v[40:41], v12 offset:256
    ds_read_b64_tr_b16 v[42:43], v12 offset:1792
    v_mfma_f32_32x32x16_bf16 v[160:175], v[60:63], v[48:51], v[160:175]
    ds_read_b64_tr_b16 v[44:45], v13 offset:0
    ds_read_b64_tr_b16 v[46:47], v13 offset:256
    v_mfma_f32_32x32x16_bf16 v[176:191], v[60:63], v[52:55], v[176:191]
    v_mfma_f32_32x32x16_bf16 v[192:207], v[64:67], v[48:51], v[192:207]
    v_mfma_f32_32x32x16_bf16 v[208:223], v[64:67], v[52:55], v[208:223]
    v_mfma_f32_32x32x16_bf16 v[224:239], v[68:71], v[52:55], v[224:239]
    s_add_u32 s27, s27, 1
    s_cmp_lt_u32 s27, 18
    s_cbranch_scc1 k1loop_13
    s_branch lw1_12
lw0_11:
k1loop_15:
    s_waitcnt lgkmcnt(0)
    ds_read_b128 v[48:51], v11 offset:0
    ds_read_b128 v[52:55], v11 offset:2048
    ds_read_b64_tr_b16 v[56:57], v12 offset:6144
    ds_read_b64_tr_b16 v[58:59], v12 offset:7680
    v_mfma_f32_32x32x16_bf16 v[128:143], v[32:35], v[24:27], v[128:143]
    ds_read_b64_tr_b16 v[60:61], v12 offset:6272
    ds_read_b64_tr_b16 v[62:63], v12 offset:7808
    s_add_u32 m0, s30, s33
    s_nop 0
    buffer_load_dwordx4 v4, s[8:11], s28 offen lds
    v_mfma_f32_32x32x16_bf16 v[144:159], v[32:35], v[28:31], v[144:159]
    ds_read_b64_tr_b16 v[64:65], v12 offset:6400
    ds_read_b64_tr_b16 v[66:67], v12 offset:7936
    s_add_u32 m0, m0, 1024
    s_nop 0
    buffer_load_dwordx4 v5, s[8:11], s28 offen lds
    v_mfma_f32_32x32x16_bf16 v[160:175], v[36:39], v[24:27], v[160:175]
    ds_read_b64_tr_b16 v[68:69], v13 offset:1024
    ds_read_b64_tr_b16 v[70:71], v13 offset:1280
    s_add_u32 m0, s30, s34
    s_nop 0
    buffer_load_dwordx4 v6, s[12:15], s29 offen lds
    v_mfma_f32_32x32x16_bf16 v[176:191], v[36:39], v[28:31], v[176:191]
    s_cmp_ge_u32 s24, 4
    s_cbranch_scc1 w2_16
    s_add_u32 m0, m0, 8192
    s_nop 0
    buffer_load_dwordx4 v7, s[12:15], s29 offen lds
w2_16:
    v_mfma_f32_32x32x16_bf16 v[192:207], v[40:43], v[24:27], v[192:207]
    s_add_u32 m0, s30, s37
    s_nop 0
    buffer_load_dword v8, s[12:15], s29 offen lds
    s_add_u32 s28, s28, 64
    s_add_u32 s29, s29, 110592
    s_add_u32 s38, s38, 1
    s_cmp_ge_u32 s38, 18
    s_cselect_b32 s28, 0x40000000, s28
    s_cselect_b32 s29, 0x40000000, s29
    s_add_u32 s30, s30, 30720
    s_cmp_eq_u32 s30, 153600
    s_cselect_b32 s30, 0, s30
    v_mfma_f32_32x32x16_bf16 v[208:223], v[40:43], v[28:31], v[208:223]
    v_mfma_f32_32x32x16_bf16 v[224:239], v[44:47], v[24:27], v[224:239]
    s_waitcnt lgkmcnt(0)
    s_waitcnt vmcnt(12)
    s_barrier
    s_add_u32 s40, s40, 30720
    s_cmp_eq_u32 s40, 153600
    s_cselect_b32 s40, 0, s40
    v_add_u32 v10, s40, v16
    v_add_u32 v11, s40, v17
    v_add_u32 v12, s40, v18
    v_add_u32 v13, s40, v19
    ds_read_b128 v[24:27], v10 offset:0
    ds_read_b128 v[28:31], v10 offset:2048
    ds_read_b64_tr_b16 v[32:33], v12 offset:0
    ds_read_b64_tr_b16 v[34:35], v12 offset:1536
    v_mfma_f32_32x32x16_bf16 v[128:143], v[56:59], v[48:51], v[128:143]
    ds_read_b64_tr_b16 v[36:37], v12 offset:128
    ds_read_b64_tr_b16 v[38:39], v12 offset:1664
    v_mfma_f32_32x32x16_bf16 v[144:159], v[56:59], v[52:55], v[144:159]
    ds_read_b64_tr_b16 v[40:41], v12 offset:256
    ds_read_b64_tr_b16 v[42:43], v12 offset:1792
    v_mfma_f32_32x32x16_bf16 v[160:175], v[60:63], v[48:51], v[160:175]
    ds_read_b64_tr_b16 v[44:45], v13 offset:0
    ds_read_b64_tr_b16 v[46:47], v13 offset:256
    v_mfma_f32_32x32x16_bf16 v[176:191], v[60:63], v[52:55], v[176:191]
    v_mfma_f32_32x32x16_bf16 v[192:207], v[64:67], v[48:51], v[192:207]
    v_mfma_f32_32x32x16_bf16 v[208:223], v[64:67], v[52:55], v[208:223]
    v_mfma_f32_32x32x16_bf16 v[224:239], v[68:71], v[48:51], v[224:239]
    s_add_u32 s27, s27, 1
    s_cmp_lt_u32 s27, 18
    s_cbranch_scc1 k1loop_15
lw1_12:
    s_waitcnt lgkmcnt(0)
    s_nop 15
    s_nop 7
    s_add_u32 s5, s31, 0
    s_add_u32 s5, s5, s39
    s_cmp_lt_u32 s5, 16
    s_cselect_b32 s6, 0x3eae1a93, 1.0
    v_mul_f32 v128, s6, v128
    v_mul_f32 v129, s6, v129
    v_mul_f32 v130, s6, v130
    v_mul_f32 v131, s6, v131
    v_mul_f32 v132, s6, v132
    v_mul_f32 v133, s6, v133
    v_mul_f32 v134, s6, v134
    v_mul_f32 v135, s6, v135
    v_mul_f32 v136, s6, v136
    v_mul_f32 v137, s6, v137
    v_mul_f32 v138, s6, v138
    v_mul_f32 v139, s6, v139
    v_mul_f32 v140, s6, v140
    v_mul_f32 v141, s6, v141
    v_mul_f32 v142, s6, v142
    v_mul_f32 v143, s6, v143
    v_cvt_pk_bf16_f32 v64, v128, v129
    v_cvt_pk_bf16_f32 v65, v130, v131
    v_cvt_pk_bf16_f32 v66, v132, v133
    v_cvt_pk_bf16_f32 v67, v134, v135
    v_cvt_pk_bf16_f32 v68, v136, v137
    v_cvt_pk_bf16_f32 v69, v138, v139
    v_cvt_pk_bf16_f32 v70, v140, v141
    v_cvt_pk_bf16_f32 v71, v142, v143
    s_nop 1
    v_permlane32_swap_b32 v64, v66
    v_permlane32_swap_b32 v65, v67
    v_permlane32_swap_b32 v68, v70
    v_permlane32_swap_b32 v69, v71
    s_add_u32 s4, s41, 0
    s_cselect_b32 s7, 0, 0
    s_cmp_lt_u32 s5, 16
    s_mov_b32 s6, 3328
    s_cselect_b32 s6, 1024, s6
    s_mul_i32 s4, s4, s6
    s_mov_b32 s6, 212992
    s_cselect_b32 s6, 65536, s6
    s_mov_b32 s7, 14417920
    s_cselect_b32 s7, 18874368, s7
    s_mul_i32 s5, s5, s6
    s_lshl_b32 s5, s5, 1
    s_add_u32 s4, s4, s5
    s_add_u32 s4, s4, s7
    s_add_u32 s5, s4, s6
    buffer_store_dwordx4 v[64:67], v15, s[16:19], s4 offen sc0 sc1
    buffer_store_dwordx4 v[68:71], v15, s[16:19], s5 offen sc0 sc1
    s_nop 1
    s_add_u32 s5, s31, 0
    s_add_u32 s5, s5, s39
    s_cmp_lt_u32 s5, 16
    s_cselect_b32 s6, 0x3eae1a93, 1.0
    v_mul_f32 v144, s6, v144
    v_mul_f32 v145, s6, v145
    v_mul_f32 v146, s6, v146
    v_mul_f32 v147, s6, v147
    v_mul_f32 v148, s6, v148
    v_mul_f32 v149, s6, v149
    v_mul_f32 v150, s6, v150
    v_mul_f32 v151, s6, v151
    v_mul_f32 v152, s6, v152
    v_mul_f32 v153, s6, v153
    v_mul_f32 v154, s6, v154
    v_mul_f32 v155, s6, v155
    v_mul_f32 v156, s6, v156
    v_mul_f32 v157, s6, v157
    v_mul_f32 v158, s6, v158
    v_mul_f32 v159, s6, v159
    v_cvt_pk_bf16_f32 v72, v144, v145
    v_cvt_pk_bf16_f32 v73, v146, v147
    v_cvt_pk_bf16_f32 v74, v148, v149
    v_cvt_pk_bf16_f32 v75, v150, v151
    v_cvt_pk_bf16_f32 v76, v152, v153
    v_cvt_pk_bf16_f32 v77, v154, v155
    v_cvt_pk_bf16_f32 v78, v156, v157
    v_cvt_pk_bf16_f32 v79, v158, v159
    s_nop 1
    v_permlane32_swap_b32 v72, v74
    v_permlane32_swap_b32 v73, v75
    v_permlane32_swap_b32 v76, v78
    v_permlane32_swap_b32 v77, v79
    s_add_u32 s4, s41, 1
    s_cselect_b32 s7, 0, 0
    s_cmp_lt_u32 s5, 16
    s_mov_b32 s6, 3328
    s_cselect_b32 s6, 1024, s6
    s_mul_i32 s4, s4, s6
    s_mov_b32 s6, 212992
    s_cselect_b32 s6, 65536, s6
    s_mov_b32 s7, 14417920
    s_cselect_b32 s7, 18874368, s7
    s_mul_i32 s5, s5, s6
    s_lshl_b32 s5, s5, 1
    s_add_u32 s4, s4, s5
    s_add_u32 s4, s4, s7
    s_add_u32 s5, s4, s6
    buffer_store_dwordx4 v[72:75], v15, s[16:19], s4 offen sc0 sc1
    buffer_store_dwordx4 v[76:79], v15, s[16:19], s5 offen sc0 sc1
    s_nop 1
    s_add_u32 s5, s31, 2
    s_add_u32 s5, s5, s39
    s_cmp_lt_u32 s5, 16
    s_cselect_b32 s6, 0x3eae1a93, 1.0
    v_mul_f32 v160, s6, v160
    v_mul_f32 v161, s6, v161
    v_mul_f32 v162, s6, v162
    v_mul_f32 v163, s6, v163
    v_mul_f32 v164, s6, v164
    v_mul_f32 v165, s6, v165
    v_mul_f32 v166, s6, v166
    v_mul_f32 v167, s6, v167
    v_mul_f32 v168, s6, v168
    v_mul_f32 v169, s6, v169
    v_mul_f32 v170, s6, v170
    v_mul_f32 v171, s6, v171
    v_mul_f32 v172, s6, v172
    v_mul_f32 v173, s6, v173
    v_mul_f32 v174, s6, v174
    v_mul_f32 v175, s6, v175
    v_cvt_pk_bf16_f32 v80, v160, v161
    v_cvt_pk_bf16_f32 v81, v162, v163
    v_cvt_pk_bf16_f32 v82, v164, v165
    v_cvt_pk_bf16_f32 v83, v166, v167
    v_cvt_pk_bf16_f32 v84, v168, v169
    v_cvt_pk_bf16_f32 v85, v170, v171
    v_cvt_pk_bf16_f32 v86, v172, v173
    v_cvt_pk_bf16_f32 v87, v174, v175
    s_nop 1
    v_permlane32_swap_b32 v80, v82
    v_permlane32_swap_b32 v81, v83
    v_permlane32_swap_b32 v84, v86
    v_permlane32_swap_b32 v85, v87
    s_add_u32 s4, s41, 0
    s_cselect_b32 s7, 0, 0
    s_cmp_lt_u32 s5, 16
    s_mov_b32 s6, 3328
    s_cselect_b32 s6, 1024, s6
    s_mul_i32 s4, s4, s6
    s_mov_b32 s6, 212992
    s_cselect_b32 s6, 65536, s6
    s_mov_b32 s7, 14417920
    s_cselect_b32 s7, 18874368, s7
    s_mul_i32 s5, s5, s6
    s_lshl_b32 s5, s5, 1
    s_add_u32 s4, s4, s5
    s_add_u32 s4, s4, s7
    s_add_u32 s5, s4, s6
    buffer_store_dwordx4 v[80:83], v15, s[16:19], s4 offen sc0 sc1
    buffer_store_dwordx4 v[84:87], v15, s[16:19], s5 offen sc0 sc1
    s_nop 1
    s_add_u32 s5, s31, 2
    s_add_u32 s5, s5, s39
    s_cmp_lt_u32 s5, 16
    s_cselect_b32 s6, 0x3eae1a93, 1.0
    v_mul_f32 v176, s6, v176
    v_mul_f32 v177, s6, v177
    v_mul_f32 v178, s6, v178
    v_mul_f32 v179, s6, v179
    v_mul_f32 v180, s6, v180
    v_mul_f32 v181, s6, v181
    v_mul_f32 v182, s6, v182
    v_mul_f32 v183, s6, v183
    v_mul_f32 v184, s6, v184
    v_mul_f32 v185, s6, v185
    v_mul_f32 v186, s6, v186
    v_mul_f32 v187, s6, v187
    v_mul_f32 v188, s6, v188
    v_mul_f32 v189, s6, v189
    v_mul_f32 v190, s6, v190
    v_mul_f32 v191, s6, v191
    v_cvt_pk_bf16_f32 v88, v176, v177
    v_cvt_pk_bf16_f32 v89, v178, v179
    v_cvt_pk_bf16_f32 v90, v180, v181
    v_cvt_pk_bf16_f32 v91, v182, v183
    v_cvt_pk_bf16_f32 v92, v184, v185
    v_cvt_pk_bf16_f32 v93, v186, v187
    v_cvt_pk_bf16_f32 v94, v188, v189
    v_cvt_pk_bf16_f32 v95, v190, v191
    s_nop 1
    v_permlane32_swap_b32 v88, v90
    v_permlane32_swap_b32 v89, v91
    v_permlane32_swap_b32 v92, v94
    v_permlane32_swap_b32 v93, v95
    s_add_u32 s4, s41, 1
    s_cselect_b32 s7, 0, 0
    s_cmp_lt_u32 s5, 16
    s_mov_b32 s6, 3328
    s_cselect_b32 s6, 1024, s6
    s_mul_i32 s4, s4, s6
    s_mov_b32 s6, 212992
    s_cselect_b32 s6, 65536, s6
    s_mov_b32 s7, 14417920
    s_cselect_b32 s7, 18874368, s7
    s_mul_i32 s5, s5, s6
    s_lshl_b32 s5, s5, 1
    s_add_u32 s4, s4, s5
    s_add_u32 s4, s4, s7
    s_add_u32 s5, s4, s6
    buffer_store_dwordx4 v[88:91], v15, s[16:19], s4 offen sc0 sc1
    buffer_store_dwordx4 v[92:95], v15, s[16:19], s5 offen sc0 sc1
    s_nop 1
    s_add_u32 s5, s31, 4
    s_add_u32 s5, s5, s39
    s_cmp_lt_u32 s5, 16
    s_cselect_b32 s6, 0x3eae1a93, 1.0
    v_mul_f32 v192, s6, v192
    v_mul_f32 v193, s6, v193
    v_mul_f32 v194, s6, v194
    v_mul_f32 v195, s6, v195
    v_mul_f32 v196, s6, v196
    v_mul_f32 v197, s6, v197
    v_mul_f32 v198, s6, v198
    v_mul_f32 v199, s6, v199
    v_mul_f32 v200, s6, v200
    v_mul_f32 v201, s6, v201
    v_mul_f32 v202, s6, v202
    v_mul_f32 v203, s6, v203
    v_mul_f32 v204, s6, v204
    v_mul_f32 v205, s6, v205
    v_mul_f32 v206, s6, v206
    v_mul_f32 v207, s6, v207
    v_cvt_pk_bf16_f32 v64, v192, v193
    v_cvt_pk_bf16_f32 v65, v194, v195
    v_cvt_pk_bf16_f32 v66, v196, v197
    v_cvt_pk_bf16_f32 v67, v198, v199
    v_cvt_pk_bf16_f32 v68, v200, v201
    v_cvt_pk_bf16_f32 v69, v202, v203
    v_cvt_pk_bf16_f32 v70, v204, v205
    v_cvt_pk_bf16_f32 v71, v206, v207
    s_nop 1
    v_permlane32_swap_b32 v64, v66
    v_permlane32_swap_b32 v65, v67
    v_permlane32_swap_b32 v68, v70
    v_permlane32_swap_b32 v69, v71
    s_add_u32 s4, s41, 0
    s_cselect_b32 s7, 0, 0
    s_cmp_lt_u32 s5, 16
    s_mov_b32 s6, 3328
    s_cselect_b32 s6, 1024, s6
    s_mul_i32 s4, s4, s6
    s_mov_b32 s6, 212992
    s_cselect_b32 s6, 65536, s6
    s_mov_b32 s7, 14417920
    s_cselect_b32 s7, 18874368, s7
    s_mul_i32 s5, s5, s6
    s_lshl_b32 s5, s5, 1
    s_add_u32 s4, s4, s5
    s_add_u32 s4, s4, s7
    s_add_u32 s5, s4, s6
    buffer_store_dwordx4 v[64:67], v15, s[16:19], s4 offen sc0 sc1
    buffer_store_dwordx4 v[68:71], v15, s[16:19], s5 offen sc0 sc1
    s_nop 1
    s_add_u32 s5, s31, 4
    s_add_u32 s5, s5, s39
    s_cmp_lt_u32 s5, 16
    s_cselect_b32 s6, 0x3eae1a93, 1.0
    v_mul_f32 v208, s6, v208
    v_mul_f32 v209, s6, v209
    v_mul_f32 v210, s6, v210
    v_mul_f32 v211, s6, v211
    v_mul_f32 v212, s6, v212
    v_mul_f32 v213, s6, v213
    v_mul_f32 v214, s6, v214
    v_mul_f32 v215, s6, v215
    v_mul_f32 v216, s6, v216
    v_mul_f32 v217, s6, v217
    v_mul_f32 v218, s6, v218
    v_mul_f32 v219, s6, v219
    v_mul_f32 v220, s6, v220
    v_mul_f32 v221, s6, v221
    v_mul_f32 v222, s6, v222
    v_mul_f32 v223, s6, v223
    v_cvt_pk_bf16_f32 v72, v208, v209
    v_cvt_pk_bf16_f32 v73, v210, v211
    v_cvt_pk_bf16_f32 v74, v212, v213
    v_cvt_pk_bf16_f32 v75, v214, v215
    v_cvt_pk_bf16_f32 v76, v216, v217
    v_cvt_pk_bf16_f32 v77, v218, v219
    v_cvt_pk_bf16_f32 v78, v220, v221
    v_cvt_pk_bf16_f32 v79, v222, v223
    s_nop 1
    v_permlane32_swap_b32 v72, v74
    v_permlane32_swap_b32 v73, v75
    v_permlane32_swap_b32 v76, v78
    v_permlane32_swap_b32 v77, v79
    s_add_u32 s4, s41, 1
    s_cselect_b32 s7, 0, 0
    s_cmp_lt_u32 s5, 16
    s_mov_b32 s6, 3328
    s_cselect_b32 s6, 1024, s6
    s_mul_i32 s4, s4, s6
    s_mov_b32 s6, 212992
    s_cselect_b32 s6, 65536, s6
    s_mov_b32 s7, 14417920
    s_cselect_b32 s7, 18874368, s7
    s_mul_i32 s5, s5, s6
    s_lshl_b32 s5, s5, 1
    s_add_u32 s4, s4, s5
    s_add_u32 s4, s4, s7
    s_add_u32 s5, s4, s6
    buffer_store_dwordx4 v[72:75], v15, s[16:19], s4 offen sc0 sc1
    buffer_store_dwordx4 v[76:79], v15, s[16:19], s5 offen sc0 sc1
    s_nop 1
    s_cmp_lt_u32 s36, 2
    s_cselect_b32 s6, 0x3eae1a93, 1.0
    v_mul_f32 v224, s6, v224
    v_mul_f32 v225, s6, v225
    v_mul_f32 v226, s6, v226
    v_mul_f32 v227, s6, v227
    v_mul_f32 v228, s6, v228
    v_mul_f32 v229, s6, v229
    v_mul_f32 v230, s6, v230
    v_mul_f32 v231, s6, v231
    v_mul_f32 v232, s6, v232
    v_mul_f32 v233, s6, v233
    v_mul_f32 v234, s6, v234
    v_mul_f32 v235, s6, v235
    v_mul_f32 v236, s6, v236
    v_mul_f32 v237, s6, v237
    v_mul_f32 v238, s6, v238
    v_mul_f32 v239, s6, v239
    v_cvt_pk_bf16_f32 v80, v224, v225
    v_cvt_pk_bf16_f32 v81, v226, v227
    v_cvt_pk_bf16_f32 v82, v228, v229
    v_cvt_pk_bf16_f32 v83, v230, v231
    v_cvt_pk_bf16_f32 v84, v232, v233
    v_cvt_pk_bf16_f32 v85, v234, v235
    v_cvt_pk_bf16_f32 v86, v236, v237
    v_cvt_pk_bf16_f32 v87, v238, v239
    s_cmp_lt_u32 s36, 2
    s_mov_b32 s7, 212992
    s_cselect_b32 s7, 8192, s7
    s_mov_b32 s5, 3328
    s_cselect_b32 s5, 128, s5
    s_mov_b32 s6, 14420992
    s_cselect_b32 s6, 20971520, s6
    s_mul_i32 s4, s32, s5
    s_add_u32 s4, s4, s6
    s_mul_i32 s5, s36, s7
    s_lshl_b32 s5, s5, 4
    s_add_u32 s4, s4, s5
    v_lshrrev_b32 v100, 5, v1
    s_lshl_b32 s5, s7, 1
    v_mul_lo_u32 v100, v100, s5
    v_and_b32 v101, 31, v1
    v_lshl_add_u32 v100, v101, 2, v100
    s_mul_i32 s5, s7, 0
    s_add_u32 s5, s5, s4
    buffer_store_dword v80, v100, s[16:19], s5 offen
    s_mul_i32 s5, s7, 1
    s_add_u32 s5, s5, s4
    buffer_store_dword v81, v100, s[16:19], s5 offen
    s_mul_i32 s5, s7, 4
    s_add_u32 s5, s5, s4
    buffer_store_dword v82, v100, s[16:19], s5 offen
    s_mul_i32 s5, s7, 5
    s_add_u32 s5, s5, s4
    buffer_store_dword v83, v100, s[16:19], s5 offen
    s_mul_i32 s5, s7, 8
    s_add_u32 s5, s5, s4
    buffer_store_dword v84, v100, s[16:19], s5 offen
    s_mul_i32 s5, s7, 9
    s_add_u32 s5, s5, s4
    buffer_store_dword v85, v100, s[16:19], s5 offen
    s_mul_i32 s5, s7, 12
    s_add_u32 s5, s5, s4
    buffer_store_dword v86, v100, s[16:19], s5 offen
    s_mul_i32 s5, s7, 13
    s_add_u32 s5, s5, s4
    buffer_store_dword v87, v100, s[16:19], s5 offen
    s_nop 1
    s_endpgm
k1_qkg:
    s_add_u32 s4, s24, 0
    s_lshl_b32 s4, s4, 6
    v_add_u32 v64, s4, v1
    s_mov_b32 s5, 2731
    v_mul_lo_u32 v65, v64, s5
    v_lshrrev_b32 v65, 16, v65
    v_mul_u32_u24 v66, 24, v65
    v_sub_u32 v66, v64, v66
    v_lshlrev_b32 v67, 1, v65
    v_and_b32 v67, 4, v67
    v_xor_b32 v66, v66, v67
    v_lshrrev_b32 v67, 1, v66
    v_mul_u32_u24 v67, 36, v67
    v_and_b32 v66, 1, v66
    v_lshl_add_u32 v66, v66, 4, v67
    v_mul_u32_u24 v65, 3456, v65
    s_mul_i32 s4, s31, 72
    v_add3_u32 v6, v65, v66, s4
    s_add_u32 s4, s24, 8
    s_lshl_b32 s4, s4, 6
    v_add_u32 v64, s4, v1
    s_mov_b32 s5, 2731
    v_mul_lo_u32 v65, v64, s5
    v_lshrrev_b32 v65, 16, v65
    v_mul_u32_u24 v66, 24, v65
    v_sub_u32 v66, v64, v66
    v_lshlrev_b32 v67, 1, v65
    v_and_b32 v67, 4, v67
    v_xor_b32 v66, v66, v67
    v_lshrrev_b32 v67, 1, v66
    v_mul_u32_u24 v67, 36, v67
    v_and_b32 v66, 1, v66
    v_lshl_add_u32 v66, v66, 4, v67
    v_mul_u32_u24 v65, 3456, v65
    s_mul_i32 s4, s31, 72
    v_add3_u32 v7, v65, v66, s4
    s_lshl_b32 s33, s24, 11
    s_lshl_b32 s34, s24, 10
    s_add_u32 s34, s34, 16384
    s_lshl_b32 s37, s24, 8
    s_add_u32 s37, s37, 28672
    s_mov_b32 s28, 0
    s_mov_b32 s29, 0
    s_mov_b32 s30, 0
    s_mov_b32 s38, 0
    s_cmp_lg_u32 s24, 0
    s_cbranch_scc1 k1_nog
    s_mov_b32 m0, 153600
    v_lshlrev_b32 v64, 4, v1
    buffer_load_dwordx4 v64, s[20:23], 0 offen lds
    s_mov_b32 m0, 154624
    v_add_u32 v64, 1024, v64
    buffer_load_dwordx4 v64, s[20:23], 0 offen lds
k1_nog:
    v_lshrrev_b32 v64, 5, v1
    v_lshlrev_b32 v64, 4, v64
    v_add_u32 v14, 153600, v64
    s_add_u32 m0, s30, s33
    s_nop 0
    buffer_load_dwordx4 v4, s[8:11], s28 offen lds
    s_add_u32 m0, m0, 1024
    s_nop 0
    buffer_load_dwordx4 v5, s[8:11], s28 offen lds
    s_add_u32 m0, s30, s34
    s_nop 0
    buffer_load_dwordx4 v6, s[12:15], s29 offen lds
    s_cmp_ge_u32 s24, 4
    s_cbranch_scc1 w2_17
    s_add_u32 m0, m0, 8192
    s_nop 0
    buffer_load_dwordx4 v7, s[12:15], s29 offen lds
w2_17:
    s_add_u32 s28, s28, 64
    s_add_u32 s29, s29, 110592
    s_add_u32 s38, s38, 1
    s_cmp_ge_u32 s38, 18
    s_cselect_b32 s28, 0x40000000, s28
    s_cselect_b32 s29, 0x40000000, s29
    s_add_u32 s30, s30, 30720
    s_cmp_eq_u32 s30, 153600
    s_cselect_b32 s30, 0, s30
    s_add_u32 m0, s30, s33
    s_nop 0
    buffer_load_dwordx4 v4, s[8:11], s28 offen lds
    s_add_u32 m0, m0, 1024
    s_nop 0
    buffer_load_dwordx4 v5, s[8:11], s28 offen lds
    s_add_u32 m0, s30, s34
    s_nop 0
    buffer_load_dwordx4 v6, s[12:15], s29 offen lds
    s_cmp_ge_u32 s24, 4
    s_cbranch_scc1 w2_18
    s_add_u32 m0, m0, 8192
    s_nop 0
    buffer_load_dwordx4 v7, s[12:15], s29 offen lds
w2_18:
    s_add_u32 s28, s28, 64
    s_add_u32 s29, s29, 110592
    s_add_u32 s38, s38, 1
    s_cmp_ge_u32 s38, 18
    s_cselect_b32 s28, 0x40000000, s28
    s_cselect_b32 s29, 0x40000000, s29
    s_add_u32 s30, s30, 30720
    s_cmp_eq_u32 s30, 153600
    s_cselect_b32 s30, 0, s30
    s_add_u32 m0, s30, s33
    s_nop 0
    buffer_load_dwordx4 v4, s[8:11], s28 offen lds
    s_add_u32 m0, m0, 1024
    s_nop 0
    buffer_load_dwordx4 v5, s[8:11], s28 offen lds
    s_add_u32 m0, s30, s34
    s_nop 0
    buffer_load_dwordx4 v6, s[12:15], s29 offen lds
    s_cmp_ge_u32 s24, 4
    s_cbranch_scc1 w2_19
    s_add_u32 m0, m0, 8192
    s_nop 0
    buffer_load_dwordx4 v7, s[12:15], s29 offen lds
w2_19:
    s_add_u32 s28, s28, 64
    s_add_u32 s29, s29, 110592
    s_add_u32 s38, s38, 1
    s_cmp_ge_u32 s38, 18
    s_cselect_b32 s28, 0x40000000, s28
    s_cselect_b32 s29, 0x40000000, s29
    s_add_u32 s30, s30, 30720
    s_cmp_eq_u32 s30, 153600
    s_cselect_b32 s30, 0, s30
    s_add_u32 m0, s30, s33
    s_nop 0
    buffer_load_dwordx4 v4, s[8:11], s28 offen lds
    s_add_u32 m0, m0, 1024
    s_nop 0
    buffer_load_dwordx4 v5, s[8:11], s28 offen lds
    s_add_u32 m0, s30, s34
    s_nop 0
    buffer_load_dwordx4 v6, s[12:15], s29 offen lds
    s_cmp_ge_u32 s24, 4
    s_cbranch_scc1 w2_20
    s_add_u32 m0, m0, 8192
    s_nop 0
    buffer_load_dwordx4 v7, s[12:15], s29 offen lds
w2_20:
    s_add_u32 s28, s28, 64
    s_add_u32 s29, s29, 110592
    s_add_u32 s38, s38, 1
    s_cmp_ge_u32 s38, 18
    s_cselect_b32 s28, 0x40000000, s28
    s_cselect_b32 s29, 0x40000000, s29
    s_add_u32 s30, s30, 30720
    s_cmp_eq_u32 s30, 153600
    s_cselect_b32 s30, 0, s30
    s_lshr_b32 s4, s2, 3
    s_mul_i32 s4, s4, 486
    v_add_u32 v64, s4, v0
    v_lshlrev_b32 v64, 7, v64
    v_mov_b32 v65, 0x7f000000
    v_cmp_gt_u32 vcc, 486, v0
    v_cndmask_b32 v64, v65, v64, vcc
    buffer_load_dword v97, v64, s[12:15], 0 offen
    v_and_b32 v64, 15, v1
    v_lshrrev_b32 v65, 5, v1
    v_lshrrev_b32 v66, 2, v64
    v_lshl_add_u32 v66, v65, 3, v66
    v_bfe_u32 v67, v1, 4, 1
    v_lshlrev_b32 v67, 5, v67
    v_and_b32 v68, 3, v64
    v_lshl_add_u32 v67, v68, 3, v67
    v_mul_u32_u24 v68, 64, v66
    v_add_u32 v19, v68, v67
    v_add_u32 v19, 28672, v19
    v_mul_u32_u24 v66, 384, v66
    v_add_u32 v66, v66, v67
    v_bfe_u32 v67, v1, 3, 1
    v_xor_b32 v67, s39, v67
    v_lshl_add_u32 v66, v67, 6, v66
    v_add_u32 v18, 16384, v66
    v_and_b32 v64, 31, v1
    v_bfe_u32 v65, v1, 2, 2
    v_lshrrev_b32 v66, 5, v1
    v_add_u32 v66, 0, v66
    v_xor_b32 v65, v65, v66
    v_lshlrev_b32 v64, 6, v64
    v_lshl_add_u32 v64, v65, 4, v64
    s_lshr_b32 s4, s24, 1
    s_lshl_b32 s4, s4, 12
    v_add_u32 v16, s4, v64
    v_and_b32 v64, 31, v1
    v_bfe_u32 v65, v1, 2, 2
    v_lshrrev_b32 v66, 5, v1
    v_add_u32 v66, 2, v66
    v_xor_b32 v65, v65, v66
    v_lshlrev_b32 v64, 6, v64
    v_lshl_add_u32 v64, v65, 4, v64
    s_lshr_b32 s4, s24, 1
    s_lshl_b32 s4, s4, 12
    v_add_u32 v17, s4, v64
    v_mov_b32 v128, 0
    v_mov_b32 v129, 0
    v_mov_b32 v130, 0
    v_mov_b32 v131, 0
    v_mov_b32 v132, 0
    v_mov_b32 v133, 0
    v_mov_b32 v134, 0
    v_mov_b32 v135, 0
    v_mov_b32 v136, 0
    v_mov_b32 v137, 0
    v_mov_b32 v138, 0
    v_mov_b32 v139, 0
    v_mov_b32 v140, 0
    v_mov_b32 v141, 0
    v_mov_b32 v142, 0
    v_mov_b32 v143, 0
    v_mov_b32 v144, 0
    v_mov_b32 v145, 0
    v_mov_b32 v146, 0
    v_mov_b32 v147, 0
    v_mov_b32 v148, 0
    v_mov_b32 v149, 0
    v_mov_b32 v150, 0
    v_mov_b32 v151, 0
    v_mov_b32 v152, 0
    v_mov_b32 v153, 0
    v_mov_b32 v154, 0
    v_mov_b32 v155, 0
    v_mov_b32 v156, 0
    v_mov_b32 v157, 0
    v_mov_b32 v158, 0
    v_mov_b32 v159, 0
    v_mov_b32 v160, 0
    v_mov_b32 v161, 0
    v_mov_b32 v162, 0
    v_mov_b32 v163, 0
    v_mov_b32 v164, 0
    v_mov_b32 v165, 0
    v_mov_b32 v166, 0
    v_mov_b32 v167, 0
    v_mov_b32 v168, 0
    v_mov_b32 v169, 0
    v_mov_b32 v170, 0
    v_mov_b32 v171, 0
    v_mov_b32 v172, 0
    v_mov_b32 v173, 0
    v_mov_b32 v174, 0
    v_mov_b32 v175, 0
    v_mov_b32 v176, 0
    v_mov_b32 v177, 0
    v_mov_b32 v178, 0
    v_mov_b32 v179, 0
    v_mov_b32 v180, 0
    v_mov_b32 v181, 0
    v_mov_b32 v182, 0
    v_mov_b32 v183, 0
    v_mov_b32 v184, 0
    v_mov_b32 v185, 0
    v_mov_b32 v186, 0
    v_mov_b32 v187, 0
    v_mov_b32 v188, 0
    v_mov_b32 v189, 0
    v_mov_b32 v190, 0
    v_mov_b32 v191, 0
    v_mov_b32 v192, 0
    v_mov_b32 v193, 0
    v_mov_b32 v194, 0
    v_mov_b32 v195, 0
    v_mov_b32 v196, 0
    v_mov_b32 v197, 0
    v_mov_b32 v198, 0
    v_mov_b32 v199, 0
    v_mov_b32 v200, 0
    v_mov_b32 v201, 0
    v_mov_b32 v202, 0
    v_mov_b32 v203, 0
    v_mov_b32 v204, 0
    v_mov_b32 v205, 0
    v_mov_b32 v206, 0
    v_mov_b32 v207, 0
    v_mov_b32 v208, 0
    v_mov_b32 v209, 0
    v_mov_b32 v210, 0
    v_mov_b32 v211, 0
    v_mov_b32 v212, 0
    v_mov_b32 v213, 0
    v_mov_b32 v214, 0
    v_mov_b32 v215, 0
    v_mov_b32 v216, 0
    v_mov_b32 v217, 0
    v_mov_b32 v218, 0
    v_mov_b32 v219, 0
    v_mov_b32 v220, 0
    v_mov_b32 v221, 0
    v_mov_b32 v222, 0
    v_mov_b32 v223, 0
    v_mov_b32 v224, 0
    v_mov_b32 v225, 0
    v_mov_b32 v226, 0
    v_mov_b32 v227, 0
    v_mov_b32 v228, 0
    v_mov_b32 v229, 0
    v_mov_b32 v230, 0
    v_mov_b32 v231, 0
    v_mov_b32 v232, 0
    v_mov_b32 v233, 0
    v_mov_b32 v234, 0
    v_mov_b32 v235, 0
    v_mov_b32 v236, 0
    v_mov_b32 v237, 0
    v_mov_b32 v238, 0
    v_mov_b32 v239, 0
    s_waitcnt vmcnt(10)
    s_barrier
    s_mov_b32 s40, 0
    v_add_u32 v10, s40, v16
    v_add_u32 v11, s40, v17
    v_add_u32 v12, s40, v18
    ds_read_b128 v[24:27], v10 offset:0
    ds_read_b128 v[28:31], v10 offset:2048
    ds_read_b64_tr_b16 v[32:33], v12 offset:0
    ds_read_b64_tr_b16 v[34:35], v12 offset:1536
    ds_read_b64_tr_b16 v[36:37], v12 offset:128
    ds_read_b64_tr_b16 v[38:39], v12 offset:1664
    ds_read_b64_tr_b16 v[40:41], v12 offset:256
    ds_read_b64_tr_b16 v[42:43], v12 offset:1792
    ds_read_b128 v[44:47], v14 offset:0
    s_mov_b32 s27, 0
    s_cmp_eq_u32 s39, 0
    s_cbranch_scc1 lw0_21
k1loop_23:
    s_waitcnt lgkmcnt(0)
    ds_read_b128 v[48:51], v11 offset:0
    ds_read_b128 v[52:55], v11 offset:2048
    ds_read_b64_tr_b16 v[56:57], v12 offset:6144
    ds_read_b64_tr_b16 v[58:59], v12 offset:7680
    v_mfma_f32_32x32x16_bf16 v[128:143], v[32:35], v[24:27], v[128:143]
    ds_read_b64_tr_b16 v[60:61], v12 offset:6272
    ds_read_b64_tr_b16 v[62:63], v12 offset:7808
    s_add_u32 m0, s30, s33
    s_nop 0
    buffer_load_dwordx4 v4, s[8:11], s28 offen lds
    v_mfma_f32_32x32x16_bf16 v[144:159], v[32:35], v[28:31], v[144:159]
    ds_read_b64_tr_b16 v[64:65], v12 offset:6400
    ds_read_b64_tr_b16 v[66:67], v12 offset:7936
    s_add_u32 m0, m0, 1024
    s_nop 0
    buffer_load_dwordx4 v5, s[8:11], s28 offen lds
    v_mfma_f32_32x32x16_bf16 v[160:175], v[36:39], v[24:27], v[160:175]
    ds_read_b128 v[68:71], v14 offset:32
    s_add_u32 m0, s30, s34
    s_nop 0
    buffer_load_dwordx4 v6, s[12:15], s29 offen lds
    v_mfma_f32_32x32x16_bf16 v[176:191], v[36:39], v[28:31], v[176:191]
    s_cmp_ge_u32 s24, 4
    s_cbranch_scc1 w2_24
    s_add_u32 m0, m0, 8192
    s_nop 0
    buffer_load_dwordx4 v7, s[12:15], s29 offen lds
w2_24:
    s_add_u32 s28, s28, 64
    s_add_u32 s29, s29, 110592
    s_add_u32 s38, s38, 1
    s_cmp_ge_u32 s38, 18
    s_cselect_b32 s28, 0x40000000, s28
    s_cselect_b32 s29, 0x40000000, s29
    s_add_u32 s30, s30, 30720
    s_cmp_eq_u32 s30, 153600
    s_cselect_b32 s30, 0, s30
    v_mfma_f32_32x32x16_bf16 v[192:207], v[40:43], v[24:27], v[192:207]
    v_mfma_f32_32x32x16_bf16 v[208:223], v[40:43], v[28:31], v[208:223]
    v_mfma_f32_32x32x16_bf16 v[224:239], v[44:47], v[28:31], v[224:239]
    s_waitcnt lgkmcnt(0)
    s_waitcnt vmcnt(9)
    s_barrier
    s_add_u32 s40, s40, 30720
    s_cmp_eq_u32 s40, 153600
    s_cselect_b32 s40, 0, s40
    v_add_u32 v10, s40, v16
    v_add_u32 v11, s40, v17
    v_add_u32 v12, s40, v18
    v_add_u32 v14, 64, v14
    ds_read_b128 v[24:27], v10 offset:0
    ds_read_b128 v[28:31], v10 offset:2048
    ds_read_b64_tr_b16 v[32:33], v12 offset:0
    ds_read_b64_tr_b16 v[34:35], v12 offset:1536
    v_mfma_f32_32x32x16_bf16 v[128:143], v[56:59], v[48:51], v[128:143]
    ds_read_b64_tr_b16 v[36:37], v12 offset:128
    ds_read_b64_tr_b16 v[38:39], v12 offset:1664
    v_mfma_f32_32x32x16_bf16 v[144:159], v[56:59], v[52:55], v[144:159]
    ds_read_b64_tr_b16 v[40:41], v12 offset:256
    ds_read_b64_tr_b16 v[42:43], v12 offset:1792
    v_mfma_f32_32x32x16_bf16 v[160:175], v[60:63], v[48:51], v[160:175]
    ds_read_b128 v[44:47], v14 offset:0
    v_mfma_f32_32x32x16_bf16 v[176:191], v[60:63], v[52:55], v[176:191]
    v_mfma_f32_32x32x16_bf16 v[192:207], v[64:67], v[48:51], v[192:207]
    v_mfma_f32_32x32x16_bf16 v[208:223], v[64:67], v[52:55], v[208:223]
    v_mfma_f32_32x32x16_bf16 v[224:239], v[68:71], v[52:55], v[224:239]
    s_add_u32 s27, s27, 1
    s_cmp_lt_u32 s27, 18
    s_cbranch_scc1 k1loop_23
    s_branch lw1_22
lw0_21:
k1loop_25:
    s_waitcnt lgkmcnt(0)
    ds_read_b128 v[48:51], v11 offset:0
    ds_read_b128 v[52:55], v11 offset:2048
    ds_read_b64_tr_b16 v[56:57], v12 offset:6144
    ds_read_b64_tr_b16 v[58:59], v12 offset:7680
    v_mfma_f32_32x32x16_bf16 v[128:143], v[32:35], v[24:27], v[128:143]
    ds_read_b64_tr_b16 v[60:61], v12 offset:6272
    ds_read_b64_tr_b16 v[62:63], v12 offset:7808
    s_add_u32 m0, s30, s33
    s_nop 0
    buffer_load_dwordx4 v4, s[8:11], s28 offen lds
    v_mfma_f32_32x32x16_bf16 v[144:159], v[32:35], v[28:31], v[144:159]
    ds_read_b64_tr_b16 v[64:65], v12 offset:6400
    ds_read_b64_tr_b16 v[66:67], v12 offset:7936
    s_add_u32 m0, m0, 1024
    s_nop 0
    buffer_load_dwordx4 v5, s[8:11], s28 offen lds
    v_mfma_f32_32x32x16_bf16 v[160:175], v[36:39], v[24:27], v[160:175]
    ds_read_b128 v[68:71], v14 offset:32
    s_add_u32 m0, s30, s34
    s_nop 0
    buffer_load_dwordx4 v6, s[12:15], s29 offen lds
    v_mfma_f32_32x32x16_bf16 v[176:191], v[36:39], v[28:31], v[176:191]
    s_cmp_ge_u32 s24, 4
    s_cbranch_scc1 w2_26
    s_add_u32 m0, m0, 8192
    s_nop 0
    buffer_load_dwordx4 v7, s[12:15], s29 offen lds
w2_26:
    s_add_u32 s28, s28, 64
    s_add_u32 s29, s29, 110592
    s_add_u32 s38, s38, 1
    s_cmp_ge_u32 s38, 18
    s_cselect_b32 s28, 0x40000000, s28
    s_cselect_b32 s29, 0x40000000, s29
    s_add_u32 s30, s30, 30720
    s_cmp_eq_u32 s30, 153600
    s_cselect_b32 s30, 0, s30
    v_mfma_f32_32x32x16_bf16 v[192:207], v[40:43], v[24:27], v[192:207]
    v_mfma_f32_32x32x16_bf16 v[208:223], v[40:43], v[28:31], v[208:223]
    v_mfma_f32_32x32x16_bf16 v[224:239], v[44:47], v[24:27], v[224:239]
    s_waitcnt lgkmcnt(0)
    s_waitcnt vmcnt(9)
    s_barrier
    s_add_u32 s40, s40, 30720
    s_cmp_eq_u32 s40, 153600
    s_cselect_b32 s40, 0, s40
    v_add_u32 v10, s40, v16
    v_add_u32 v11, s40, v17
    v_add_u32 v12, s40, v18
    v_add_u32 v14, 64, v14
    ds_read_b128 v[24:27], v10 offset:0
    ds_read_b128 v[28:31], v10 offset:2048
    ds_read_b64_tr_b16 v[32:33], v12 offset:0
    ds_read_b64_tr_b16 v[34:35], v12 offset:1536
    v_mfma_f32_32x32x16_bf16 v[128:143], v[56:59], v[48:51], v[128:143]
    ds_read_b64_tr_b16 v[36:37], v12 offset:128
    ds_read_b64_tr_b16 v[38:39], v12 offset:1664
    v_mfma_f32_32x32x16_bf16 v[144:159], v[56:59], v[52:55], v[144:159]
    ds_read_b64_tr_b16 v[40:41], v12 offset:256
    ds_read_b64_tr_b16 v[42:43], v12 offset:1792
    v_mfma_f32_32x32x16_bf16 v[160:175], v[60:63], v[48:51], v[160:175]
    ds_read_b128 v[44:47], v14 offset:0
    v_mfma_f32_32x32x16_bf16 v[176:191], v[60:63], v[52:55], v[176:191]
    v_mfma_f32_32x32x16_bf16 v[192:207], v[64:67], v[48:51], v[192:207]
    v_mfma_f32_32x32x16_bf16 v[208:223], v[64:67], v[52:55], v[208:223]
    v_mfma_f32_32x32x16_bf16 v[224:239], v[68:71], v[48:51], v[224:239]
    s_add_u32 s27, s27, 1
    s_cmp_lt_u32 s27, 18
    s_cbranch_scc1 k1loop_25
lw1_22:
    s_waitcnt lgkmcnt(0)
    s_nop 15
    s_nop 7
    s_add_u32 s5, s31, 0
    s_add_u32 s5, s5, s39
    s_cmp_lt_u32 s5, 16
    s_cselect_b32 s6, 0x3eae1a93, 1.0
    v_mul_f32 v128, s6, v128
    v_mul_f32 v129, s6, v129
    v_mul_f32 v130, s6, v130
    v_mul_f32 v131, s6, v131
    v_mul_f32 v132, s6, v132
    v_mul_f32 v133, s6, v133
    v_mul_f32 v134, s6, v134
    v_mul_f32 v135, s6, v135
    v_mul_f32 v136, s6, v136
    v_mul_f32 v137, s6, v137
    v_mul_f32 v138, s6, v138
    v_mul_f32 v139, s6, v139
    v_mul_f32 v140, s6, v140
    v_mul_f32 v141, s6, v141
    v_mul_f32 v142, s6, v142
    v_mul_f32 v143, s6, v143
    v_cvt_pk_bf16_f32 v64, v128, v129
    v_cvt_pk_bf16_f32 v65, v130, v131
    v_cvt_pk_bf16_f32 v66, v132, v133
    v_cvt_pk_bf16_f32 v67, v134, v135
    v_cvt_pk_bf16_f32 v68, v136, v137
    v_cvt_pk_bf16_f32 v69, v138, v139
    v_cvt_pk_bf16_f32 v70, v140, v141
    v_cvt_pk_bf16_f32 v71, v142, v143
    s_nop 1
    v_permlane32_swap_b32 v64, v66
    v_permlane32_swap_b32 v65, v67
    v_permlane32_swap_b32 v68, v70
    v_permlane32_swap_b32 v69, v71
    s_add_u32 s4, s41, 0
    s_cselect_b32 s7, 0, 0
    s_cmp_lt_u32 s5, 16
    s_mov_b32 s6, 3328
    s_cselect_b32 s6, 1024, s6
    s_mul_i32 s4, s4, s6
    s_mov_b32 s6, 212992
    s_cselect_b32 s6, 65536, s6
    s_mov_b32 s7, 14417920
    s_cselect_b32 s7, 18874368, s7
    s_mul_i32 s5, s5, s6
    s_lshl_b32 s5, s5, 1
    s_add_u32 s4, s4, s5
    s_add_u32 s4, s4, s7
    s_add_u32 s5, s4, s6
    buffer_store_dwordx4 v[64:67], v15, s[16:19], s4 offen sc0 sc1
    buffer_store_dwordx4 v[68:71], v15, s[16:19], s5 offen sc0 sc1
    s_nop 1
    s_add_u32 s5, s31, 0
    s_add_u32 s5, s5, s39
    s_cmp_lt_u32 s5, 16
    s_cselect_b32 s6, 0x3eae1a93, 1.0
    v_mul_f32 v144, s6, v144
    v_mul_f32 v145, s6, v145
    v_mul_f32 v146, s6, v146
    v_mul_f32 v147, s6, v147
    v_mul_f32 v148, s6, v148
    v_mul_f32 v149, s6, v149
    v_mul_f32 v150, s6, v150
    v_mul_f32 v151, s6, v151
    v_mul_f32 v152, s6, v152
    v_mul_f32 v153, s6, v153
    v_mul_f32 v154, s6, v154
    v_mul_f32 v155, s6, v155
    v_mul_f32 v156, s6, v156
    v_mul_f32 v157, s6, v157
    v_mul_f32 v158, s6, v158
    v_mul_f32 v159, s6, v159
    v_cvt_pk_bf16_f32 v72, v144, v145
    v_cvt_pk_bf16_f32 v73, v146, v147
    v_cvt_pk_bf16_f32 v74, v148, v149
    v_cvt_pk_bf16_f32 v75, v150, v151
    v_cvt_pk_bf16_f32 v76, v152, v153
    v_cvt_pk_bf16_f32 v77, v154, v155
    v_cvt_pk_bf16_f32 v78, v156, v157
    v_cvt_pk_bf16_f32 v79, v158, v159
    s_nop 1
    v_permlane32_swap_b32 v72, v74
    v_permlane32_swap_b32 v73, v75
    v_permlane32_swap_b32 v76, v78
    v_permlane32_swap_b32 v77, v79
    s_add_u32 s4, s41, 1
    s_cselect_b32 s7, 0, 0
    s_cmp_lt_u32 s5, 16
    s_mov_b32 s6, 3328
    s_cselect_b32 s6, 1024, s6
    s_mul_i32 s4, s4, s6
    s_mov_b32 s6, 212992
    s_cselect_b32 s6, 65536, s6
    s_mov_b32 s7, 14417920
    s_cselect_b32 s7, 18874368, s7
    s_mul_i32 s5, s5, s6
    s_lshl_b32 s5, s5, 1
    s_add_u32 s4, s4, s5
    s_add_u32 s4, s4, s7
    s_add_u32 s5, s4, s6
    buffer_store_dwordx4 v[72:75], v15, s[16:19], s4 offen sc0 sc1
    buffer_store_dwordx4 v[76:79], v15, s[16:19], s5 offen sc0 sc1
    s_nop 1
    s_add_u32 s5, s31, 2
    s_add_u32 s5, s5, s39
    s_cmp_lt_u32 s5, 16
    s_cselect_b32 s6, 0x3eae1a93, 1.0
    v_mul_f32 v160, s6, v160
    v_mul_f32 v161, s6, v161
    v_mul_f32 v162, s6, v162
    v_mul_f32 v163, s6, v163
    v_mul_f32 v164, s6, v164
    v_mul_f32 v165, s6, v165
    v_mul_f32 v166, s6, v166
    v_mul_f32 v167, s6, v167
    v_mul_f32 v168, s6, v168
    v_mul_f32 v169, s6, v169
    v_mul_f32 v170, s6, v170
    v_mul_f32 v171, s6, v171
    v_mul_f32 v172, s6, v172
    v_mul_f32 v173, s6, v173
    v_mul_f32 v174, s6, v174
    v_mul_f32 v175, s6, v175
    v_cvt_pk_bf16_f32 v80, v160, v161
    v_cvt_pk_bf16_f32 v81, v162, v163
    v_cvt_pk_bf16_f32 v82, v164, v165
    v_cvt_pk_bf16_f32 v83, v166, v167
    v_cvt_pk_bf16_f32 v84, v168, v169
    v_cvt_pk_bf16_f32 v85, v170, v171
    v_cvt_pk_bf16_f32 v86, v172, v173
    v_cvt_pk_bf16_f32 v87, v174, v175
    s_nop 1
    v_permlane32_swap_b32 v80, v82
    v_permlane32_swap_b32 v81, v83
    v_permlane32_swap_b32 v84, v86
    v_permlane32_swap_b32 v85, v87
    s_add_u32 s4, s41, 0
    s_cselect_b32 s7, 0, 0
    s_cmp_lt_u32 s5, 16
    s_mov_b32 s6, 3328
    s_cselect_b32 s6, 1024, s6
    s_mul_i32 s4, s4, s6
    s_mov_b32 s6, 212992
    s_cselect_b32 s6, 65536, s6
    s_mov_b32 s7, 14417920
    s_cselect_b32 s7, 18874368, s7
    s_mul_i32 s5, s5, s6
    s_lshl_b32 s5, s5, 1
    s_add_u32 s4, s4, s5
    s_add_u32 s4, s4, s7
    s_add_u32 s5, s4, s6
    buffer_store_dwordx4 v[80:83], v15, s[16:19], s4 offen sc0 sc1
    buffer_store_dwordx4 v[84:87], v15, s[16:19], s5 offen sc0 sc1
    s_nop 1
    s_add_u32 s5, s31, 2
    s_add_u32 s5, s5, s39
    s_cmp_lt_u32 s5, 16
    s_cselect_b32 s6, 0x3eae1a93, 1.0
    v_mul_f32 v176, s6, v176
    v_mul_f32 v177, s6, v177
    v_mul_f32 v178, s6, v178
    v_mul_f32 v179, s6, v179
    v_mul_f32 v180, s6, v180
    v_mul_f32 v181, s6, v181
    v_mul_f32 v182, s6, v182
    v_mul_f32 v183, s6, v183
    v_mul_f32 v184, s6, v184
    v_mul_f32 v185, s6, v185
    v_mul_f32 v186, s6, v186
    v_mul_f32 v187, s6, v187
    v_mul_f32 v188, s6, v188
    v_mul_f32 v189, s6, v189
    v_mul_f32 v190, s6, v190
    v_mul_f32 v191, s6, v191
    v_cvt_pk_bf16_f32 v88, v176, v177
    v_cvt_pk_bf16_f32 v89, v178, v179
    v_cvt_pk_bf16_f32 v90, v180, v181
    v_cvt_pk_bf16_f32 v91, v182, v183
    v_cvt_pk_bf16_f32 v92, v184, v185
    v_cvt_pk_bf16_f32 v93, v186, v187
    v_cvt_pk_bf16_f32 v94, v188, v189
    v_cvt_pk_bf16_f32 v95, v190, v191
    s_nop 1
    v_permlane32_swap_b32 v88, v90
    v_permlane32_swap_b32 v89, v91
    v_permlane32_swap_b32 v92, v94
    v_permlane32_swap_b32 v93, v95
    s_add_u32 s4, s41, 1
    s_cselect_b32 s7, 0, 0
    s_cmp_lt_u32 s5, 16
    s_mov_b32 s6, 3328
    s_cselect_b32 s6, 1024, s6
    s_mul_i32 s4, s4, s6
    s_mov_b32 s6, 212992
    s_cselect_b32 s6, 65536, s6
    s_mov_b32 s7, 14417920
    s_cselect_b32 s7, 18874368, s7
    s_mul_i32 s5, s5, s6
    s_lshl_b32 s5, s5, 1
    s_add_u32 s4, s4, s5
    s_add_u32 s4, s4, s7
    s_add_u32 s5, s4, s6
    buffer_store_dwordx4 v[88:91], v15, s[16:19], s4 offen sc0 sc1
    buffer_store_dwordx4 v[92:95], v15, s[16:19], s5 offen sc0 sc1
    s_nop 1
    s_add_u32 s5, s31, 4
    s_add_u32 s5, s5, s39
    s_cmp_lt_u32 s5, 16
    s_cselect_b32 s6, 0x3eae1a93, 1.0
    v_mul_f32 v192, s6, v192
    v_mul_f32 v193, s6, v193
    v_mul_f32 v194, s6, v194
    v_mul_f32 v195, s6, v195
    v_mul_f32 v196, s6, v196
    v_mul_f32 v197, s6, v197
    v_mul_f32 v198, s6, v198
    v_mul_f32 v199, s6, v199
    v_mul_f32 v200, s6, v200
    v_mul_f32 v201, s6, v201
    v_mul_f32 v202, s6, v202
    v_mul_f32 v203, s6, v203
    v_mul_f32 v204, s6, v204
    v_mul_f32 v205, s6, v205
    v_mul_f32 v206, s6, v206
    v_mul_f32 v207, s6, v207
    v_cvt_pk_bf16_f32 v64, v192, v193
    v_cvt_pk_bf16_f32 v65, v194, v195
    v_cvt_pk_bf16_f32 v66, v196, v197
    v_cvt_pk_bf16_f32 v67, v198, v199
    v_cvt_pk_bf16_f32 v68, v200, v201
    v_cvt_pk_bf16_f32 v69, v202, v203
    v_cvt_pk_bf16_f32 v70, v204, v205
    v_cvt_pk_bf16_f32 v71, v206, v207
    s_nop 1
    v_permlane32_swap_b32 v64, v66
    v_permlane32_swap_b32 v65, v67
    v_permlane32_swap_b32 v68, v70
    v_permlane32_swap_b32 v69, v71
    s_add_u32 s4, s41, 0
    s_cselect_b32 s7, 0, 0
    s_cmp_lt_u32 s5, 16
    s_mov_b32 s6, 3328
    s_cselect_b32 s6, 1024, s6
    s_mul_i32 s4, s4, s6
    s_mov_b32 s6, 212992
    s_cselect_b32 s6, 65536, s6
    s_mov_b32 s7, 14417920
    s_cselect_b32 s7, 18874368, s7
    s_mul_i32 s5, s5, s6
    s_lshl_b32 s5, s5, 1
    s_add_u32 s4, s4, s5
    s_add_u32 s4, s4, s7
    s_add_u32 s5, s4, s6
    buffer_store_dwordx4 v[64:67], v15, s[16:19], s4 offen sc0 sc1
    buffer_store_dwordx4 v[68:71], v15, s[16:19], s5 offen sc0 sc1
    s_nop 1
    s_add_u32 s5, s31, 4
    s_add_u32 s5, s5, s39
    s_cmp_lt_u32 s5, 16
    s_cselect_b32 s6, 0x3eae1a93, 1.0
    v_mul_f32 v208, s6, v208
    v_mul_f32 v209, s6, v209
    v_mul_f32 v210, s6, v210
    v_mul_f32 v211, s6, v211
    v_mul_f32 v212, s6, v212
    v_mul_f32 v213, s6, v213
    v_mul_f32 v214, s6, v214
    v_mul_f32 v215, s6, v215
    v_mul_f32 v216, s6, v216
    v_mul_f32 v217, s6, v217
    v_mul_f32 v218, s6, v218
    v_mul_f32 v219, s6, v219
    v_mul_f32 v220, s6, v220
    v_mul_f32 v221, s6, v221
    v_mul_f32 v222, s6, v222
    v_mul_f32 v223, s6, v223
    v_cvt_pk_bf16_f32 v72, v208, v209
    v_cvt_pk_bf16_f32 v73, v210, v211
    v_cvt_pk_bf16_f32 v74, v212, v213
    v_cvt_pk_bf16_f32 v75, v214, v215
    v_cvt_pk_bf16_f32 v76, v216, v217
    v_cvt_pk_bf16_f32 v77, v218, v219
    v_cvt_pk_bf16_f32 v78, v220, v221
    v_cvt_pk_bf16_f32 v79, v222, v223
    s_nop 1
    v_permlane32_swap_b32 v72, v74
    v_permlane32_swap_b32 v73, v75
    v_permlane32_swap_b32 v76, v78
    v_permlane32_swap_b32 v77, v79
    s_add_u32 s4, s41, 1
    s_cselect_b32 s7, 0, 0
    s_cmp_lt_u32 s5, 16
    s_mov_b32 s6, 3328
    s_cselect_b32 s6, 1024, s6
    s_mul_i32 s4, s4, s6
    s_mov_b32 s6, 212992
    s_cselect_b32 s6, 65536, s6
    s_mov_b32 s7, 14417920
    s_cselect_b32 s7, 18874368, s7
    s_mul_i32 s5, s5, s6
    s_lshl_b32 s5, s5, 1
    s_add_u32 s4, s4, s5
    s_add_u32 s4, s4, s7
    s_add_u32 s5, s4, s6
    buffer_store_dwordx4 v[72:75], v15, s[16:19], s4 offen sc0 sc1
    buffer_store_dwordx4 v[76:79], v15, s[16:19], s5 offen sc0 sc1
    s_nop 1
    v_mul_f32 v100, 0xbfb8aa3b, v224
    v_exp_f32 v100, v100
    s_nop 0
    v_add_f32 v100, 1.0, v100
    v_rcp_f32 v100, v100
    v_and_b32 v101, 31, v1
    v_lshlrev_b32 v101, 2, v101
    s_lshl_b32 s4, s32, 7
    s_add_u32 s4, s4, 28114944
    s_nop 0
    buffer_store_dword v100, v101, s[16:19], s4 offen
    s_nop 1
    s_endpgm
k1_mix:
    s_add_u32 s4, s24, 0
    s_lshl_b32 s4, s4, 6
    v_add_u32 v64, s4, v1
    s_mov_b32 s5, 2731
    v_mul_lo_u32 v65, v64, s5
    v_lshrrev_b32 v65, 16, v65
    v_mul_u32_u24 v66, 24, v65
    v_sub_u32 v66, v64, v66
    v_lshlrev_b32 v67, 1, v65
    v_and_b32 v67, 4, v67
    v_xor_b32 v66, v66, v67
    v_lshrrev_b32 v67, 1, v66
    v_mul_u32_u24 v67, 36, v67
    v_and_b32 v66, 1, v66
    v_lshl_add_u32 v66, v66, 4, v67
    v_mul_u32_u24 v65, 3456, v65
    s_mul_i32 s4, s31, 72
    v_add3_u32 v6, v65, v66, s4
    s_add_u32 s4, s24, 8
    s_lshl_b32 s4, s4, 6
    v_add_u32 v64, s4, v1
    s_mov_b32 s5, 2731
    v_mul_lo_u32 v65, v64, s5
    v_lshrrev_b32 v65, 16, v65
    v_mul_u32_u24 v66, 24, v65
    v_sub_u32 v66, v64, v66
    v_lshlrev_b32 v67, 1, v65
    v_and_b32 v67, 4, v67
    v_xor_b32 v66, v66, v67
    v_lshrrev_b32 v67, 1, v66
    v_mul_u32_u24 v67, 36, v67
    v_and_b32 v66, 1, v66
    v_lshl_add_u32 v66, v66, 4, v67
    v_mul_u32_u24 v65, 3456, v65
    s_mul_i32 s4, s31, 72
    v_add3_u32 v7, v65, v66, s4
    s_lshl_b32 s33, s24, 11
    s_lshl_b32 s34, s24, 10
    s_add_u32 s34, s34, 16384
    s_lshl_b32 s37, s24, 8
    s_add_u32 s37, s37, 28672
    s_mov_b32 s28, 0
    s_mov_b32 s29, 0
    s_mov_b32 s30, 0
    s_mov_b32 s38, 0
    s_add_u32 m0, s30, s33
    s_nop 0
    buffer_load_dwordx4 v4, s[8:11], s28 offen lds
    s_add_u32 m0, m0, 1024
    s_nop 0
    buffer_load_dwordx4 v5, s[8:11], s28 offen lds
    s_add_u32 m0, s30, s34
    s_nop 0
    buffer_load_dwordx4 v6, s[12:15], s29 offen lds
    s_cmp_ge_u32 s24, 4
    s_cbranch_scc1 w2_27
    s_add_u32 m0, m0, 8192
    s_nop 0
    buffer_load_dwordx4 v7, s[12:15], s29 offen lds
w2_27:
    s_add_u32 s28, s28, 64
    s_add_u32 s29, s29, 110592
    s_add_u32 s38, s38, 1
    s_cmp_ge_u32 s38, 18
    s_cselect_b32 s28, 0x40000000, s28
    s_cselect_b32 s29, 0x40000000, s29
    s_add_u32 s30, s30, 30720
    s_cmp_eq_u32 s30, 153600
    s_cselect_b32 s30, 0, s30
    s_add_u32 m0, s30, s33
    s_nop 0
    buffer_load_dwordx4 v4, s[8:11], s28 offen lds
    s_add_u32 m0, m0, 1024
    s_nop 0
    buffer_load_dwordx4 v5, s[8:11], s28 offen lds
    s_add_u32 m0, s30, s34
    s_nop 0
    buffer_load_dwordx4 v6, s[12:15], s29 offen lds
    s_cmp_ge_u32 s24, 4
    s_cbranch_scc1 w2_28
    s_add_u32 m0, m0, 8192
    s_nop 0
    buffer_load_dwordx4 v7, s[12:15], s29 offen lds
w2_28:
    s_add_u32 s28, s28, 64
    s_add_u32 s29, s29, 110592
    s_add_u32 s38, s38, 1
    s_cmp_ge_u32 s38, 18
    s_cselect_b32 s28, 0x40000000, s28
    s_cselect_b32 s29, 0x40000000, s29
    s_add_u32 s30, s30, 30720
    s_cmp_eq_u32 s30, 153600
    s_cselect_b32 s30, 0, s30
    s_add_u32 m0, s30, s33
    s_nop 0
    buffer_load_dwordx4 v4, s[8:11], s28 offen lds
    s_add_u32 m0, m0, 1024
    s_nop 0
    buffer_load_dwordx4 v5, s[8:11], s28 offen lds
    s_add_u32 m0, s30, s34
    s_nop 0
    buffer_load_dwordx4 v6, s[12:15], s29 offen lds
    s_cmp_ge_u32 s24, 4
    s_cbranch_scc1 w2_29
    s_add_u32 m0, m0, 8192
    s_nop 0
    buffer_load_dwordx4 v7, s[12:15], s29 offen lds
w2_29:
    s_add_u32 s28, s28, 64
    s_add_u32 s29, s29, 110592
    s_add_u32 s38, s38, 1
    s_cmp_ge_u32 s38, 18
    s_cselect_b32 s28, 0x40000000, s28
    s_cselect_b32 s29, 0x40000000, s29
    s_add_u32 s30, s30, 30720
    s_cmp_eq_u32 s30, 153600
    s_cselect_b32 s30, 0, s30
    s_add_u32 m0, s30, s33
    s_nop 0
    buffer_load_dwordx4 v4, s[8:11], s28 offen lds
    s_add_u32 m0, m0, 1024
    s_nop 0
    buffer_load_dwordx4 v5, s[8:11], s28 offen lds
    s_add_u32 m0, s30, s34
    s_nop 0
    buffer_load_dwordx4 v6, s[12:15], s29 offen lds
    s_cmp_ge_u32 s24, 4
    s_cbranch_scc1 w2_30
    s_add_u32 m0, m0, 8192
    s_nop 0
    buffer_load_dwordx4 v7, s[12:15], s29 offen lds
w2_30:
    s_add_u32 s28, s28, 64
    s_add_u32 s29, s29, 110592
    s_add_u32 s38, s38, 1
    s_cmp_ge_u32 s38, 18
    s_cselect_b32 s28, 0x40000000, s28
    s_cselect_b32 s29, 0x40000000, s29
    s_add_u32 s30, s30, 30720
    s_cmp_eq_u32 s30, 153600
    s_cselect_b32 s30, 0, s30
    s_lshr_b32 s4, s2, 3
    s_mul_i32 s4, s4, 486
    v_add_u32 v64, s4, v0
    v_lshlrev_b32 v64, 7, v64
    v_mov_b32 v65, 0x7f000000
    v_cmp_gt_u32 vcc, 486, v0
    v_cndmask_b32 v64, v65, v64, vcc
    buffer_load_dword v97, v64, s[12:15], 0 offen
    v_and_b32 v64, 15, v1
    v_lshrrev_b32 v65, 5, v1
    v_lshrrev_b32 v66, 2, v64
    v_lshl_add_u32 v66, v65, 3, v66
    v_bfe_u32 v67, v1, 4, 1
    v_lshlrev_b32 v67, 5, v67
    v_and_b32 v68, 3, v64
    v_lshl_add_u32 v67, v68, 3, v67
    v_mul_u32_u24 v68, 64, v66
    v_add_u32 v19, v68, v67
    v_add_u32 v19, 28672, v19
    v_mul_u32_u24 v66, 384, v66
    v_add_u32 v66, v66, v67
    v_bfe_u32 v67, v1, 3, 1
    v_xor_b32 v67, s39, v67
    v_lshl_add_u32 v66, v67, 6, v66
    v_add_u32 v18, 16384, v66
    v_and_b32 v64, 31, v1
    v_bfe_u32 v65, v1, 2, 2
    v_lshrrev_b32 v66, 5, v1
    v_add_u32 v66, 0, v66
    v_xor_b32 v65, v65, v66
    v_lshlrev_b32 v64, 6, v64
    v_lshl_add_u32 v64, v65, 4, v64
    s_lshr_b32 s4, s24, 1
    s_lshl_b32 s4, s4, 12
    v_add_u32 v16, s4, v64
    v_and_b32 v64, 31, v1
    v_bfe_u32 v65, v1, 2, 2
    v_lshrrev_b32 v66, 5, v1
    v_add_u32 v66, 2, v66
    v_xor_b32 v65, v65, v66
    v_lshlrev_b32 v64, 6, v64
    v_lshl_add_u32 v64, v65, 4, v64
    s_lshr_b32 s4, s24, 1
    s_lshl_b32 s4, s4, 12
    v_add_u32 v17, s4, v64
    v_mov_b32 v128, 0
    v_mov_b32 v129, 0
    v_mov_b32 v130, 0
    v_mov_b32 v131, 0
    v_mov_b32 v132, 0
    v_mov_b32 v133, 0
    v_mov_b32 v134, 0
    v_mov_b32 v135, 0
    v_mov_b32 v136, 0
    v_mov_b32 v137, 0
    v_mov_b32 v138, 0
    v_mov_b32 v139, 0
    v_mov_b32 v140, 0
    v_mov_b32 v141, 0
    v_mov_b32 v142, 0
    v_mov_b32 v143, 0
    v_mov_b32 v144, 0
    v_mov_b32 v145, 0
    v_mov_b32 v146, 0
    v_mov_b32 v147, 0
    v_mov_b32 v148, 0
    v_mov_b32 v149, 0
    v_mov_b32 v150, 0
    v_mov_b32 v151, 0
    v_mov_b32 v152, 0
    v_mov_b32 v153, 0
    v_mov_b32 v154, 0
    v_mov_b32 v155, 0
    v_mov_b32 v156, 0
    v_mov_b32 v157, 0
    v_mov_b32 v158, 0
    v_mov_b32 v159, 0
    v_mov_b32 v160, 0
    v_mov_b32 v161, 0
    v_mov_b32 v162, 0
    v_mov_b32 v163, 0
    v_mov_b32 v164, 0
    v_mov_b32 v165, 0
    v_mov_b32 v166, 0
    v_mov_b32 v167, 0
    v_mov_b32 v168, 0
    v_mov_b32 v169, 0
    v_mov_b32 v170, 0
    v_mov_b32 v171, 0
    v_mov_b32 v172, 0
    v_mov_b32 v173, 0
    v_mov_b32 v174, 0
    v_mov_b32 v175, 0
    v_mov_b32 v176, 0
    v_mov_b32 v177, 0
    v_mov_b32 v178, 0
    v_mov_b32 v179, 0
    v_mov_b32 v180, 0
    v_mov_b32 v181, 0
    v_mov_b32 v182, 0
    v_mov_b32 v183, 0
    v_mov_b32 v184, 0
    v_mov_b32 v185, 0
    v_mov_b32 v186, 0
    v_mov_b32 v187, 0
    v_mov_b32 v188, 0
    v_mov_b32 v189, 0
    v_mov_b32 v190, 0
    v_mov_b32 v191, 0
    v_mov_b32 v192, 0
    v_mov_b32 v193, 0
    v_mov_b32 v194, 0
    v_mov_b32 v195, 0
    v_mov_b32 v196, 0
    v_mov_b32 v197, 0
    v_mov_b32 v198, 0
    v_mov_b32 v199, 0
    v_mov_b32 v200, 0
    v_mov_b32 v201, 0
    v_mov_b32 v202, 0
    v_mov_b32 v203, 0
    v_mov_b32 v204, 0
    v_mov_b32 v205, 0
    v_mov_b32 v206, 0
    v_mov_b32 v207, 0
    v_mov_b32 v208, 0
    v_mov_b32 v209, 0
    v_mov_b32 v210, 0
    v_mov_b32 v211, 0
    v_mov_b32 v212, 0
    v_mov_b32 v213, 0
    v_mov_b32 v214, 0
    v_mov_b32 v215, 0
    v_mov_b32 v216, 0
    v_mov_b32 v217, 0
    v_mov_b32 v218, 0
    v_mov_b32 v219, 0
    v_mov_b32 v220, 0
    v_mov_b32 v221, 0
    v_mov_b32 v222, 0
    v_mov_b32 v223, 0
    s_waitcnt vmcnt(10)
    s_barrier
    s_mov_b32 s40, 0
    v_add_u32 v10, s40, v16
    v_add_u32 v11, s40, v17
    v_add_u32 v12, s40, v18
    ds_read_b128 v[24:27], v10 offset:0
    ds_read_b128 v[28:31], v10 offset:2048
    ds_read_b64_tr_b16 v[32:33], v12 offset:0
    ds_read_b64_tr_b16 v[34:35], v12 offset:1536
    ds_read_b64_tr_b16 v[36:37], v12 offset:128
    ds_read_b64_tr_b16 v[38:39], v12 offset:1664
    ds_read_b64_tr_b16 v[40:41], v12 offset:256
    ds_read_b64_tr_b16 v[42:43], v12 offset:1792
    s_mov_b32 s27, 0
k1loop_31:
    s_waitcnt lgkmcnt(0)
    ds_read_b128 v[48:51], v11 offset:0
    ds_read_b128 v[52:55], v11 offset:2048
    ds_read_b64_tr_b16 v[56:57], v12 offset:6144
    ds_read_b64_tr_b16 v[58:59], v12 offset:7680
    v_mfma_f32_32x32x16_bf16 v[128:143], v[32:35], v[24:27], v[128:143]
    ds_read_b64_tr_b16 v[60:61], v12 offset:6272
    ds_read_b64_tr_b16 v[62:63], v12 offset:7808
    s_add_u32 m0, s30, s33
    s_nop 0
    buffer_load_dwordx4 v4, s[8:11], s28 offen lds
    v_mfma_f32_32x32x16_bf16 v[144:159], v[32:35], v[28:31], v[144:159]
    ds_read_b64_tr_b16 v[64:65], v12 offset:6400
    ds_read_b64_tr_b16 v[66:67], v12 offset:7936
    s_add_u32 m0, m0, 1024
    s_nop 0
    buffer_load_dwordx4 v5, s[8:11], s28 offen lds
    v_mfma_f32_32x32x16_bf16 v[160:175], v[24:27], v[36:39], v[160:175]
    s_add_u32 m0, s30, s34
    s_nop 0
    buffer_load_dwordx4 v6, s[12:15], s29 offen lds
    v_mfma_f32_32x32x16_bf16 v[176:191], v[28:31], v[36:39], v[176:191]
    s_cmp_ge_u32 s24, 4
    s_cbranch_scc1 w2_32
    s_add_u32 m0, m0, 8192
    s_nop 0
    buffer_load_dwordx4 v7, s[12:15], s29 offen lds
w2_32:
    s_add_u32 s28, s28, 64
    s_add_u32 s29, s29, 110592
    s_add_u32 s38, s38, 1
    s_cmp_ge_u32 s38, 18
    s_cselect_b32 s28, 0x40000000, s28
    s_cselect_b32 s29, 0x40000000, s29
    s_add_u32 s30, s30, 30720
    s_cmp_eq_u32 s30, 153600
    s_cselect_b32 s30, 0, s30
    v_mfma_f32_32x32x16_bf16 v[192:207], v[24:27], v[40:43], v[192:207]
    v_mfma_f32_32x32x16_bf16 v[208:223], v[28:31], v[40:43], v[208:223]
    s_waitcnt lgkmcnt(0)
    s_waitcnt vmcnt(9)
    s_barrier
    s_add_u32 s40, s40, 30720
    s_cmp_eq_u32 s40, 153600
    s_cselect_b32 s40, 0, s40
    v_add_u32 v10, s40, v16
    v_add_u32 v11, s40, v17
    v_add_u32 v12, s40, v18
    ds_read_b128 v[24:27], v10 offset:0
    ds_read_b128 v[28:31], v10 offset:2048
    ds_read_b64_tr_b16 v[32:33], v12 offset:0
    ds_read_b64_tr_b16 v[34:35], v12 offset:1536
    v_mfma_f32_32x32x16_bf16 v[128:143], v[56:59], v[48:51], v[128:143]
    ds_read_b64_tr_b16 v[36:37], v12 offset:128
    ds_read_b64_tr_b16 v[38:39], v12 offset:1664
    v_mfma_f32_32x32x16_bf16 v[144:159], v[56:59], v[52:55], v[144:159]
    ds_read_b64_tr_b16 v[40:41], v12 offset:256
    ds_read_b64_tr_b16 v[42:43], v12 offset:1792
    v_mfma_f32_32x32x16_bf16 v[160:175], v[48:51], v[60:63], v[160:175]
    v_mfma_f32_32x32x16_bf16 v[176:191], v[52:55], v[60:63], v[176:191]
    v_mfma_f32_32x32x16_bf16 v[192:207], v[48:51], v[64:67], v[192:207]
    v_mfma_f32_32x32x16_bf16 v[208:223], v[52:55], v[64:67], v[208:223]
    s_add_u32 s27, s27, 1
    s_cmp_lt_u32 s27, 18
    s_cbranch_scc1 k1loop_31
    s_waitcnt lgkmcnt(0)
    s_nop 15
    s_nop 7
    s_add_u32 s5, s31, 0
    s_add_u32 s5, s5, s39
    s_cmp_lt_u32 s5, 16
    s_cselect_b32 s6, 0x3eae1a93, 1.0
    v_mul_f32 v128, s6, v128
    v_mul_f32 v129, s6, v129
    v_mul_f32 v130, s6, v130
    v_mul_f32 v131, s6, v131
    v_mul_f32 v132, s6, v132
    v_mul_f32 v133, s6, v133
    v_mul_f32 v134, s6, v134
    v_mul_f32 v135, s6, v135
    v_mul_f32 v136, s6, v136
    v_mul_f32 v137, s6, v137
    v_mul_f32 v138, s6, v138
    v_mul_f32 v139, s6, v139
    v_mul_f32 v140, s6, v140
    v_mul_f32 v141, s6, v141
    v_mul_f32 v142, s6, v142
    v_mul_f32 v143, s6, v143
    v_cvt_pk_bf16_f32 v64, v128, v129
    v_cvt_pk_bf16_f32 v65, v130, v131
    v_cvt_pk_bf16_f32 v66, v132, v133
    v_cvt_pk_bf16_f32 v67, v134, v135
    v_cvt_pk_bf16_f32 v68, v136, v137
    v_cvt_pk_bf16_f32 v69, v138, v139
    v_cvt_pk_bf16_f32 v70, v140, v141
    v_cvt_pk_bf16_f32 v71, v142, v143
    s_nop 1
    v_permlane32_swap_b32 v64, v66
    v_permlane32_swap_b32 v65, v67
    v_permlane32_swap_b32 v68, v70
    v_permlane32_swap_b32 v69, v71
    s_add_u32 s4, s41, 0
    s_cselect_b32 s7, 0, 0
    s_cmp_lt_u32 s5, 16
    s_mov_b32 s6, 3328
    s_cselect_b32 s6, 1024, s6
    s_mul_i32 s4, s4, s6
    s_mov_b32 s6, 212992
    s_cselect_b32 s6, 65536, s6
    s_mov_b32 s7, 14417920
    s_cselect_b32 s7, 18874368, s7
    s_mul_i32 s5, s5, s6
    s_lshl_b32 s5, s5, 1
    s_add_u32 s4, s4, s5
    s_add_u32 s4, s4, s7
    s_add_u32 s5, s4, s6
    buffer_store_dwordx4 v[64:67], v15, s[16:19], s4 offen sc0 sc1
    buffer_store_dwordx4 v[68:71], v15, s[16:19], s5 offen sc0 sc1
    s_nop 1
    s_add_u32 s5, s31, 0
    s_add_u32 s5, s5, s39
    s_cmp_lt_u32 s5, 16
    s_cselect_b32 s6, 0x3eae1a93, 1.0
    v_mul_f32 v144, s6, v144
    v_mul_f32 v145, s6, v145
    v_mul_f32 v146, s6, v146
    v_mul_f32 v147, s6, v147
    v_mul_f32 v148, s6, v148
    v_mul_f32 v149, s6, v149
    v_mul_f32 v150, s6, v150
    v_mul_f32 v151, s6, v151
    v_mul_f32 v152, s6, v152
    v_mul_f32 v153, s6, v153
    v_mul_f32 v154, s6, v154
    v_mul_f32 v155, s6, v155
    v_mul_f32 v156, s6, v156
    v_mul_f32 v157, s6, v157
    v_mul_f32 v158, s6, v158
    v_mul_f32 v159, s6, v159
    v_cvt_pk_bf16_f32 v72, v144, v145
    v_cvt_pk_bf16_f32 v73, v146, v147
    v_cvt_pk_bf16_f32 v74, v148, v149
    v_cvt_pk_bf16_f32 v75, v150, v151
    v_cvt_pk_bf16_f32 v76, v152, v153
    v_cvt_pk_bf16_f32 v77, v154, v155
    v_cvt_pk_bf16_f32 v78, v156, v157
    v_cvt_pk_bf16_f32 v79, v158, v159
    s_nop 1
    v_permlane32_swap_b32 v72, v74
    v_permlane32_swap_b32 v73, v75
    v_permlane32_swap_b32 v76, v78
    v_permlane32_swap_b32 v77, v79
    s_add_u32 s4, s41, 1
    s_cselect_b32 s7, 0, 0
    s_cmp_lt_u32 s5, 16
    s_mov_b32 s6, 3328
    s_cselect_b32 s6, 1024, s6
    s_mul_i32 s4, s4, s6
    s_mov_b32 s6, 212992
    s_cselect_b32 s6, 65536, s6
    s_mov_b32 s7, 14417920
    s_cselect_b32 s7, 18874368, s7
    s_mul_i32 s5, s5, s6
    s_lshl_b32 s5, s5, 1
    s_add_u32 s4, s4, s5
    s_add_u32 s4, s4, s7
    s_add_u32 s5, s4, s6
    buffer_store_dwordx4 v[72:75], v15, s[16:19], s4 offen sc0 sc1
    buffer_store_dwordx4 v[76:79], v15, s[16:19], s5 offen sc0 sc1
    s_nop 1
    v_cvt_pk_bf16_f32 v80, v160, v161
    v_cvt_pk_bf16_f32 v81, v162, v163
    v_cvt_pk_bf16_f32 v82, v164, v165
    v_cvt_pk_bf16_f32 v83, v166, v167
    v_cvt_pk_bf16_f32 v84, v168, v169
    v_cvt_pk_bf16_f32 v85, v170, v171
    v_cvt_pk_bf16_f32 v86, v172, v173
    v_cvt_pk_bf16_f32 v87, v174, v175
    v_bfe_u32 v100, v1, 4, 1
    v_mul_u32_u24 v100, 212992, v100
    v_and_b32 v101, 47, v1
    v_lshl_add_u32 v100, v101, 4, v100
    s_add_u32 s5, s31, 2
    s_add_u32 s5, s5, s39
    s_sub_u32 s5, s5, 32
    s_mul_i32 s5, s5, 425984
    s_add_u32 s4, s41, 0
    s_mul_i32 s4, s4, 3328
    s_add_u32 s4, s4, s5
    s_add_u32 s4, s4, 21234688
    buffer_store_dwordx4 v[80:83], v100, s[16:19], s4 offen sc0 sc1
    buffer_store_dwordx4 v[84:87], v100, s[16:19], s4 offen offset:1024 sc0 sc1
    s_nop 1
    v_cvt_pk_bf16_f32 v88, v176, v177
    v_cvt_pk_bf16_f32 v89, v178, v179
    v_cvt_pk_bf16_f32 v90, v180, v181
    v_cvt_pk_bf16_f32 v91, v182, v183
    v_cvt_pk_bf16_f32 v92, v184, v185
    v_cvt_pk_bf16_f32 v93, v186, v187
    v_cvt_pk_bf16_f32 v94, v188, v189
    v_cvt_pk_bf16_f32 v95, v190, v191
    v_bfe_u32 v100, v1, 4, 1
    v_mul_u32_u24 v100, 212992, v100
    v_and_b32 v101, 47, v1
    v_lshl_add_u32 v100, v101, 4, v100
    s_add_u32 s5, s31, 2
    s_add_u32 s5, s5, s39
    s_sub_u32 s5, s5, 32
    s_mul_i32 s5, s5, 425984
    s_add_u32 s4, s41, 1
    s_mul_i32 s4, s4, 3328
    s_add_u32 s4, s4, s5
    s_add_u32 s4, s4, 21234688
    buffer_store_dwordx4 v[88:91], v100, s[16:19], s4 offen sc0 sc1
    buffer_store_dwordx4 v[92:95], v100, s[16:19], s4 offen offset:1024 sc0 sc1
    s_nop 1
    v_cvt_pk_bf16_f32 v64, v192, v193
    v_cvt_pk_bf16_f32 v65, v194, v195
    v_cvt_pk_bf16_f32 v66, v196, v197
    v_cvt_pk_bf16_f32 v67, v198, v199
    v_cvt_pk_bf16_f32 v68, v200, v201
    v_cvt_pk_bf16_f32 v69, v202, v203
    v_cvt_pk_bf16_f32 v70, v204, v205
    v_cvt_pk_bf16_f32 v71, v206, v207
    v_bfe_u32 v100, v1, 4, 1
    v_mul_u32_u24 v100, 212992, v100
    v_and_b32 v101, 47, v1
    v_lshl_add_u32 v100, v101, 4, v100
    s_add_u32 s5, s31, 4
    s_add_u32 s5, s5, s39
    s_sub_u32 s5, s5, 32
    s_mul_i32 s5, s5, 425984
    s_add_u32 s4, s41, 0
    s_mul_i32 s4, s4, 3328
    s_add_u32 s4, s4, s5
    s_add_u32 s4, s4, 21234688
    buffer_store_dwordx4 v[64:67], v100, s[16:19], s4 offen sc0 sc1
    buffer_store_dwordx4 v[68:71], v100, s[16:19], s4 offen offset:1024 sc0 sc1
    s_nop 1
    v_cvt_pk_bf16_f32 v72, v208, v209
    v_cvt_pk_bf16_f32 v73, v210, v211
    v_cvt_pk_bf16_f32 v74, v212, v213
    v_cvt_pk_bf16_f32 v75, v214, v215
    v_cvt_pk_bf16_f32 v76, v216, v217
    v_cvt_pk_bf16_f32 v77, v218, v219
    v_cvt_pk_bf16_f32 v78, v220, v221
    v_cvt_pk_bf16_f32 v79, v222, v223
    v_bfe_u32 v100, v1, 4, 1
    v_mul_u32_u24 v100, 212992, v100
    v_and_b32 v101, 47, v1
    v_lshl_add_u32 v100, v101, 4, v100
    s_add_u32 s5, s31, 4
    s_add_u32 s5, s5, s39
    s_sub_u32 s5, s5, 32
    s_mul_i32 s5, s5, 425984
    s_add_u32 s4, s41, 1
    s_mul_i32 s4, s4, 3328
    s_add_u32 s4, s4, s5
    s_add_u32 s4, s4, 21234688
    buffer_store_dwordx4 v[72:75], v100, s[16:19], s4 offen sc0 sc1
    buffer_store_dwordx4 v[76:79], v100, s[16:19], s4 offen offset:1024 sc0 sc1
    s_nop 1
    s_endpgm
k1_vl:
    s_add_u32 s4, s24, 0
    s_lshl_b32 s4, s4, 6
    v_add_u32 v64, s4, v1
    s_mov_b32 s5, 2731
    v_mul_lo_u32 v65, v64, s5
    v_lshrrev_b32 v65, 16, v65
    v_mul_u32_u24 v66, 24, v65
    v_sub_u32 v66, v64, v66
    v_lshlrev_b32 v67, 1, v65
    v_and_b32 v67, 4, v67
    v_xor_b32 v66, v66, v67
    v_lshrrev_b32 v67, 1, v66
    v_mul_u32_u24 v67, 36, v67
    v_and_b32 v66, 1, v66
    v_lshl_add_u32 v66, v66, 4, v67
    v_mul_u32_u24 v65, 3456, v65
    s_mul_i32 s4, s31, 72
    v_add3_u32 v6, v65, v66, s4
    s_add_u32 s4, s24, 8
    s_lshl_b32 s4, s4, 6
    v_add_u32 v64, s4, v1
    s_mov_b32 s5, 2731
    v_mul_lo_u32 v65, v64, s5
    v_lshrrev_b32 v65, 16, v65
    v_mul_u32_u24 v66, 24, v65
    v_sub_u32 v66, v64, v66
    v_lshlrev_b32 v67, 1, v65
    v_and_b32 v67, 4, v67
    v_xor_b32 v66, v66, v67
    v_lshrrev_b32 v67, 1, v66
    v_mul_u32_u24 v67, 36, v67
    v_and_b32 v66, 1, v66
    v_lshl_add_u32 v66, v66, 4, v67
    v_mul_u32_u24 v65, 3456, v65
    s_mul_i32 s4, s31, 72
    v_add3_u32 v7, v65, v66, s4
    s_lshl_b32 s4, s24, 2
    v_lshrrev_b32 v64, 4, v1
    v_add_u32 v64, s4, v64
    v_mul_u32_u24 v64, 3456, v64
    v_and_b32 v65, 15, v1
    v_mul_u32_u24 v65, 36, v65
    s_mul_i32 s4, s36, 576
    s_add_u32 s4, s4, 32
    v_add3_u32 v8, v64, v65, s4
    s_lshl_b32 s33, s24, 11
    s_lshl_b32 s34, s24, 10
    s_add_u32 s34, s34, 16384
    s_lshl_b32 s37, s24, 8
    s_add_u32 s37, s37, 28672
    s_mov_b32 s28, 0
    s_mov_b32 s29, 0
    s_mov_b32 s30, 0
    s_mov_b32 s38, 0
    s_add_u32 m0, s30, s33
    s_nop 0
    buffer_load_dwordx4 v4, s[8:11], s28 offen lds
    s_add_u32 m0, m0, 1024
    s_nop 0
    buffer_load_dwordx4 v5, s[8:11], s28 offen lds
    s_add_u32 m0, s30, s34
    s_nop 0
    buffer_load_dwordx4 v6, s[12:15], s29 offen lds
    s_cmp_ge_u32 s24, 4
    s_cbranch_scc1 w2_33
    s_add_u32 m0, m0, 8192
    s_nop 0
    buffer_load_dwordx4 v7, s[12:15], s29 offen lds
w2_33:
    s_add_u32 m0, s30, s37
    s_nop 0
    buffer_load_dword v8, s[12:15], s29 offen lds
    s_add_u32 s28, s28, 64
    s_add_u32 s29, s29, 110592
    s_add_u32 s38, s38, 1
    s_cmp_ge_u32 s38, 18
    s_cselect_b32 s28, 0x40000000, s28
    s_cselect_b32 s29, 0x40000000, s29
    s_add_u32 s30, s30, 30720
    s_cmp_eq_u32 s30, 153600
    s_cselect_b32 s30, 0, s30
    s_add_u32 m0, s30, s33
    s_nop 0
    buffer_load_dwordx4 v4, s[8:11], s28 offen lds
    s_add_u32 m0, m0, 1024
    s_nop 0
    buffer_load_dwordx4 v5, s[8:11], s28 offen lds
    s_add_u32 m0, s30, s34
    s_nop 0
    buffer_load_dwordx4 v6, s[12:15], s29 offen lds
    s_cmp_ge_u32 s24, 4
    s_cbranch_scc1 w2_34
    s_add_u32 m0, m0, 8192
    s_nop 0
    buffer_load_dwordx4 v7, s[12:15], s29 offen lds
w2_34:
    s_add_u32 m0, s30, s37
    s_nop 0
    buffer_load_dword v8, s[12:15], s29 offen lds
    s_add_u32 s28, s28, 64
    s_add_u32 s29, s29, 110592
    s_add_u32 s38, s38, 1
    s_cmp_ge_u32 s38, 18
    s_cselect_b32 s28, 0x40000000, s28
    s_cselect_b32 s29, 0x40000000, s29
    s_add_u32 s30, s30, 30720
    s_cmp_eq_u32 s30, 153600
    s_cselect_b32 s30, 0, s30
    s_add_u32 m0, s30, s33
    s_nop 0
    buffer_load_dwordx4 v4, s[8:11], s28 offen lds
    s_add_u32 m0, m0, 1024
    s_nop 0
    buffer_load_dwordx4 v5, s[8:11], s28 offen lds
    s_add_u32 m0, s30, s34
    s_nop 0
    buffer_load_dwordx4 v6, s[12:15], s29 offen lds
    s_cmp_ge_u32 s24, 4
    s_cbranch_scc1 w2_35
    s_add_u32 m0, m0, 8192
    s_nop 0
    buffer_load_dwordx4 v7, s[12:15], s29 offen lds
w2_35:
    s_add_u32 m0, s30, s37
    s_nop 0
    buffer_load_dword v8, s[12:15], s29 offen lds
    s_add_u32 s28, s28, 64
    s_add_u32 s29, s29, 110592
    s_add_u32 s38, s38, 1
    s_cmp_ge_u32 s38, 18
    s_cselect_b32 s28, 0x40000000, s28
    s_cselect_b32 s29, 0x40000000, s29
    s_add_u32 s30, s30, 30720
    s_cmp_eq_u32 s30, 153600
    s_cselect_b32 s30, 0, s30
    s_add_u32 m0, s30, s33
    s_nop 0
    buffer_load_dwordx4 v4, s[8:11], s28 offen lds
    s_add_u32 m0, m0, 1024
    s_nop 0
    buffer_load_dwordx4 v5, s[8:11], s28 offen lds
    s_add_u32 m0, s30, s34
    s_nop 0
    buffer_load_dwordx4 v6, s[12:15], s29 offen lds
    s_cmp_ge_u32 s24, 4
    s_cbranch_scc1 w2_36
    s_add_u32 m0, m0, 8192
    s_nop 0
    buffer_load_dwordx4 v7, s[12:15], s29 offen lds
w2_36:
    s_add_u32 m0, s30, s37
    s_nop 0
    buffer_load_dword v8, s[12:15], s29 offen lds
    s_add_u32 s28, s28, 64
    s_add_u32 s29, s29, 110592
    s_add_u32 s38, s38, 1
    s_cmp_ge_u32 s38, 18
    s_cselect_b32 s28, 0x40000000, s28
    s_cselect_b32 s29, 0x40000000, s29
    s_add_u32 s30, s30, 30720
    s_cmp_eq_u32 s30, 153600
    s_cselect_b32 s30, 0, s30
    s_lshr_b32 s4, s2, 3
    s_mul_i32 s4, s4, 486
    v_add_u32 v64, s4, v0
    v_lshlrev_b32 v64, 7, v64
    v_mov_b32 v65, 0x7f000000
    v_cmp_gt_u32 vcc, 486, v0
    v_cndmask_b32 v64, v65, v64, vcc
    buffer_load_dword v97, v64, s[12:15], 0 offen
    v_and_b32 v64, 15, v1
    v_lshrrev_b32 v65, 5, v1
    v_lshrrev_b32 v66, 2, v64
    v_lshl_add_u32 v66, v65, 3, v66
    v_bfe_u32 v67, v1, 4, 1
    v_lshlrev_b32 v67, 5, v67
    v_and_b32 v68, 3, v64
    v_lshl_add_u32 v67, v68, 3, v67
    v_mul_u32_u24 v68, 64, v66
    v_add_u32 v19, v68, v67
    v_add_u32 v19, 28672, v19
    v_mul_u32_u24 v66, 384, v66
    v_add_u32 v66, v66, v67
    v_bfe_u32 v67, v1, 3, 1
    v_xor_b32 v67, s39, v67
    v_lshl_add_u32 v66, v67, 6, v66
    v_add_u32 v18, 16384, v66
    v_and_b32 v64, 31, v1
    v_bfe_u32 v65, v1, 2, 2
    v_lshrrev_b32 v66, 5, v1
    v_add_u32 v66, 0, v66
    v_xor_b32 v65, v65, v66
    v_lshlrev_b32 v64, 6, v64
    v_lshl_add_u32 v64, v65, 4, v64
    s_lshr_b32 s4, s24, 1
    s_lshl_b32 s4, s4, 12
    v_add_u32 v16, s4, v64
    v_and_b32 v64, 31, v1
    v_bfe_u32 v65, v1, 2, 2
    v_lshrrev_b32 v66, 5, v1
    v_add_u32 v66, 2, v66
    v_xor_b32 v65, v65, v66
    v_lshlrev_b32 v64, 6, v64
    v_lshl_add_u32 v64, v65, 4, v64
    s_lshr_b32 s4, s24, 1
    s_lshl_b32 s4, s4, 12
    v_add_u32 v17, s4, v64
    v_mov_b32 v128, 0
    v_mov_b32 v129, 0
    v_mov_b32 v130, 0
    v_mov_b32 v131, 0
    v_mov_b32 v132, 0
    v_mov_b32 v133, 0
    v_mov_b32 v134, 0
    v_mov_b32 v135, 0
    v_mov_b32 v136, 0
    v_mov_b32 v137, 0
    v_mov_b32 v138, 0
    v_mov_b32 v139, 0
    v_mov_b32 v140, 0
    v_mov_b32 v141, 0
    v_mov_b32 v142, 0
    v_mov_b32 v143, 0
    v_mov_b32 v144, 0
    v_mov_b32 v145, 0
    v_mov_b32 v146, 0
    v_mov_b32 v147, 0
    v_mov_b32 v148, 0
    v_mov_b32 v149, 0
    v_mov_b32 v150, 0
    v_mov_b32 v151, 0
    v_mov_b32 v152, 0
    v_mov_b32 v153, 0
    v_mov_b32 v154, 0
    v_mov_b32 v155, 0
    v_mov_b32 v156, 0
    v_mov_b32 v157, 0
    v_mov_b32 v158, 0
    v_mov_b32 v159, 0
    v_mov_b32 v160, 0
    v_mov_b32 v161, 0
    v_mov_b32 v162, 0
    v_mov_b32 v163, 0
    v_mov_b32 v164, 0
    v_mov_b32 v165, 0
    v_mov_b32 v166, 0
    v_mov_b32 v167, 0
    v_mov_b32 v168, 0
    v_mov_b32 v169, 0
    v_mov_b32 v170, 0
    v_mov_b32 v171, 0
    v_mov_b32 v172, 0
    v_mov_b32 v173, 0
    v_mov_b32 v174, 0
    v_mov_b32 v175, 0
    v_mov_b32 v176, 0
    v_mov_b32 v177, 0
    v_mov_b32 v178, 0
    v_mov_b32 v179, 0
    v_mov_b32 v180, 0
    v_mov_b32 v181, 0
    v_mov_b32 v182, 0
    v_mov_b32 v183, 0
    v_mov_b32 v184, 0
    v_mov_b32 v185, 0
    v_mov_b32 v186, 0
    v_mov_b32 v187, 0
    v_mov_b32 v188, 0
    v_mov_b32 v189, 0
    v_mov_b32 v190, 0
    v_mov_b32 v191, 0
    v_mov_b32 v192, 0
    v_mov_b32 v193, 0
    v_mov_b32 v194, 0
    v_mov_b32 v195, 0
    v_mov_b32 v196, 0
    v_mov_b32 v197, 0
    v_mov_b32 v198, 0
    v_mov_b32 v199, 0
    v_mov_b32 v200, 0
    v_mov_b32 v201, 0
    v_mov_b32 v202, 0
    v_mov_b32 v203, 0
    v_mov_b32 v204, 0
    v_mov_b32 v205, 0
    v_mov_b32 v206, 0
    v_mov_b32 v207, 0
    v_mov_b32 v208, 0
    v_mov_b32 v209, 0
    v_mov_b32 v210, 0
    v_mov_b32 v211, 0
    v_mov_b32 v212, 0
    v_mov_b32 v213, 0
    v_mov_b32 v214, 0
    v_mov_b32 v215, 0
    v_mov_b32 v216, 0
    v_mov_b32 v217, 0
    v_mov_b32 v218, 0
    v_mov_b32 v219, 0
    v_mov_b32 v220, 0
    v_mov_b32 v221, 0
    v_mov_b32 v222, 0
    v_mov_b32 v223, 0
    v_mov_b32 v224, 0
    v_mov_b32 v225, 0
    v_mov_b32 v226, 0
    v_mov_b32 v227, 0
    v_mov_b32 v228, 0
    v_mov_b32 v229, 0
    v_mov_b32 v230, 0
    v_mov_b32 v231, 0
    v_mov_b32 v232, 0
    v_mov_b32 v233, 0
    v_mov_b32 v234, 0
    v_mov_b32 v235, 0
    v_mov_b32 v236, 0
    v_mov_b32 v237, 0
    v_mov_b32 v238, 0
    v_mov_b32 v239, 0
    s_waitcnt vmcnt(13)
    s_barrier
    s_mov_b32 s40, 0
    v_add_u32 v10, s40, v16
    v_add_u32 v11, s40, v17
    v_add_u32 v12, s40, v18
    v_add_u32 v13, s40, v19
    ds_read_b128 v[24:27], v10 offset:0
    ds_read_b128 v[28:31], v10 offset:2048
    ds_read_b64_tr_b16 v[32:33], v12 offset:0
    ds_read_b64_tr_b16 v[34:35], v12 offset:1536
    ds_read_b64_tr_b16 v[36:37], v12 offset:128
    ds_read_b64_tr_b16 v[38:39], v12 offset:1664
    ds_read_b64_tr_b16 v[40:41], v12 offset:256
    ds_read_b64_tr_b16 v[42:43], v12 offset:1792
    ds_read_b64_tr_b16 v[44:45], v13 offset:0
    ds_read_b64_tr_b16 v[46:47], v13 offset:256
    s_mov_b32 s27, 0
    s_cmp_eq_u32 s39, 0
    s_cbranch_scc1 lw0_37
k1loop_39:
    s_waitcnt lgkmcnt(0)
    ds_read_b128 v[48:51], v11 offset:0
    ds_read_b128 v[52:55], v11 offset:2048
    ds_read_b64_tr_b16 v[56:57], v12 offset:6144
    ds_read_b64_tr_b16 v[58:59], v12 offset:7680
    v_mfma_f32_32x32x16_bf16 v[128:143], v[24:27], v[32:35], v[128:143]
    ds_read_b64_tr_b16 v[60:61], v12 offset:6272
    ds_read_b64_tr_b16 v[62:63], v12 offset:7808
    s_add_u32 m0, s30, s33
    s_nop 0
    buffer_load_dwordx4 v4, s[8:11], s28 offen lds
    v_mfma_f32_32x32x16_bf16 v[144:159], v[28:31], v[32:35], v[144:159]
    ds_read_b64_tr_b16 v[64:65], v12 offset:6400
    ds_read_b64_tr_b16 v[66:67], v12 offset:7936
    s_add_u32 m0, m0, 1024
    s_nop 0
    buffer_load_dwordx4 v5, s[8:11], s28 offen lds
    v_mfma_f32_32x32x16_bf16 v[160:175], v[24:27], v[36:39], v[160:175]
    ds_read_b64_tr_b16 v[68:69], v13 offset:1024
    ds_read_b64_tr_b16 v[70:71], v13 offset:1280
    s_add_u32 m0, s30, s34
    s_nop 0
    buffer_load_dwordx4 v6, s[12:15], s29 offen lds
    v_mfma_f32_32x32x16_bf16 v[176:191], v[28:31], v[36:39], v[176:191]
    s_cmp_ge_u32 s24, 4
    s_cbranch_scc1 w2_40
    s_add_u32 m0, m0, 8192
    s_nop 0
    buffer_load_dwordx4 v7, s[12:15], s29 offen lds
w2_40:
    v_mfma_f32_32x32x16_bf16 v[192:207], v[24:27], v[40:43], v[192:207]
    s_add_u32 m0, s30, s37
    s_nop 0
    buffer_load_dword v8, s[12:15], s29 offen lds
    s_add_u32 s28, s28, 64
    s_add_u32 s29, s29, 110592
    s_add_u32 s38, s38, 1
    s_cmp_ge_u32 s38, 18
    s_cselect_b32 s28, 0x40000000, s28
    s_cselect_b32 s29, 0x40000000, s29
    s_add_u32 s30, s30, 30720
    s_cmp_eq_u32 s30, 153600
    s_cselect_b32 s30, 0, s30
    v_mfma_f32_32x32x16_bf16 v[208:223], v[28:31], v[40:43], v[208:223]
    v_mfma_f32_32x32x16_bf16 v[224:239], v[28:31], v[44:47], v[224:239]
    s_waitcnt lgkmcnt(0)
    s_waitcnt vmcnt(12)
    s_barrier
    s_add_u32 s40, s40, 30720
    s_cmp_eq_u32 s40, 153600
    s_cselect_b32 s40, 0, s40
    v_add_u32 v10, s40, v16
    v_add_u32 v11, s40, v17
    v_add_u32 v12, s40, v18
    v_add_u32 v13, s40, v19
    ds_read_b128 v[24:27], v10 offset:0
    ds_read_b128 v[28:31], v10 offset:2048
    ds_read_b64_tr_b16 v[32:33], v12 offset:0
    ds_read_b64_tr_b16 v[34:35], v12 offset:1536
    v_mfma_f32_32x32x16_bf16 v[128:143], v[48:51], v[56:59], v[128:143]
    ds_read_b64_tr_b16 v[36:37], v12 offset:128
    ds_read_b64_tr_b16 v[38:39], v12 offset:1664
    v_mfma_f32_32x32x16_bf16 v[144:159], v[52:55], v[56:59], v[144:159]
    ds_read_b64_tr_b16 v[40:41], v12 offset:256
    ds_read_b64_tr_b16 v[42:43], v12 offset:1792
    v_mfma_f32_32x32x16_bf16 v[160:175], v[48:51], v[60:63], v[160:175]
    ds_read_b64_tr_b16 v[44:45], v13 offset:0
    ds_read_b64_tr_b16 v[46:47], v13 offset:256
    v_mfma_f32_32x32x16_bf16 v[176:191], v[52:55], v[60:63], v[176:191]
    v_mfma_f32_32x32x16_bf16 v[192:207], v[48:51], v[64:67], v[192:207]
    v_mfma_f32_32x32x16_bf16 v[208:223], v[52:55], v[64:67], v[208:223]
    v_mfma_f32_32x32x16_bf16 v[224:239], v[52:55], v[68:71], v[224:239]
    s_add_u32 s27, s27, 1
    s_cmp_lt_u32 s27, 18
    s_cbranch_scc1 k1loop_39
    s_branch lw1_38
lw0_37:
k1loop_41:
    s_waitcnt lgkmcnt(0)
    ds_read_b128 v[48:51], v11 offset:0
    ds_read_b128 v[52:55], v11 offset:2048
    ds_read_b64_tr_b16 v[56:57], v12 offset:6144
    ds_read_b64_tr_b16 v[58:59], v12 offset:7680
    v_mfma_f32_32x32x16_bf16 v[128:143], v[24:27], v[32:35], v[128:143]
    ds_read_b64_tr_b16 v[60:61], v12 offset:6272
    ds_read_b64_tr_b16 v[62:63], v12 offset:7808
    s_add_u32 m0, s30, s33
    s_nop 0
    buffer_load_dwordx4 v4, s[8:11], s28 offen lds
    v_mfma_f32_32x32x16_bf16 v[144:159], v[28:31], v[32:35], v[144:159]
    ds_read_b64_tr_b16 v[64:65], v12 offset:6400
    ds_read_b64_tr_b16 v[66:67], v12 offset:7936
    s_add_u32 m0, m0, 1024
    s_nop 0
    buffer_load_dwordx4 v5, s[8:11], s28 offen lds
    v_mfma_f32_32x32x16_bf16 v[160:175], v[24:27], v[36:39], v[160:175]
    ds_read_b64_tr_b16 v[68:69], v13 offset:1024
    ds_read_b64_tr_b16 v[70:71], v13 offset:1280
    s_add_u32 m0, s30, s34
    s_nop 0
    buffer_load_dwordx4 v6, s[12:15], s29 offen lds
    v_mfma_f32_32x32x16_bf16 v[176:191], v[28:31], v[36:39], v[176:191]
    s_cmp_ge_u32 s24, 4
    s_cbranch_scc1 w2_42
    s_add_u32 m0, m0, 8192
    s_nop 0
    buffer_load_dwordx4 v7, s[12:15], s29 offen lds
w2_42:
    v_mfma_f32_32x32x16_bf16 v[192:207], v[24:27], v[40:43], v[192:207]
    s_add_u32 m0, s30, s37
    s_nop 0
    buffer_load_dword v8, s[12:15], s29 offen lds
    s_add_u32 s28, s28, 64
    s_add_u32 s29, s29, 110592
    s_add_u32 s38, s38, 1
    s_cmp_ge_u32 s38, 18
    s_cselect_b32 s28, 0x40000000, s28
    s_cselect_b32 s29, 0x40000000, s29
    s_add_u32 s30, s30, 30720
    s_cmp_eq_u32 s30, 153600
    s_cselect_b32 s30, 0, s30
    v_mfma_f32_32x32x16_bf16 v[208:223], v[28:31], v[40:43], v[208:223]
    v_mfma_f32_32x32x16_bf16 v[224:239], v[24:27], v[44:47], v[224:239]
    s_waitcnt lgkmcnt(0)
    s_waitcnt vmcnt(12)
    s_barrier
    s_add_u32 s40, s40, 30720
    s_cmp_eq_u32 s40, 153600
    s_cselect_b32 s40, 0, s40
    v_add_u32 v10, s40, v16
    v_add_u32 v11, s40, v17
    v_add_u32 v12, s40, v18
    v_add_u32 v13, s40, v19
    ds_read_b128 v[24:27], v10 offset:0
    ds_read_b128 v[28:31], v10 offset:2048
    ds_read_b64_tr_b16 v[32:33], v12 offset:0
    ds_read_b64_tr_b16 v[34:35], v12 offset:1536
    v_mfma_f32_32x32x16_bf16 v[128:143], v[48:51], v[56:59], v[128:143]
    ds_read_b64_tr_b16 v[36:37], v12 offset:128
    ds_read_b64_tr_b16 v[38:39], v12 offset:1664
    v_mfma_f32_32x32x16_bf16 v[144:159], v[52:55], v[56:59], v[144:159]
    ds_read_b64_tr_b16 v[40:41], v12 offset:256
    ds_read_b64_tr_b16 v[42:43], v12 offset:1792
    v_mfma_f32_32x32x16_bf16 v[160:175], v[48:51], v[60:63], v[160:175]
    ds_read_b64_tr_b16 v[44:45], v13 offset:0
    ds_read_b64_tr_b16 v[46:47], v13 offset:256
    v_mfma_f32_32x32x16_bf16 v[176:191], v[52:55], v[60:63], v[176:191]
    v_mfma_f32_32x32x16_bf16 v[192:207], v[48:51], v[64:67], v[192:207]
    v_mfma_f32_32x32x16_bf16 v[208:223], v[52:55], v[64:67], v[208:223]
    v_mfma_f32_32x32x16_bf16 v[224:239], v[48:51], v[68:71], v[224:239]
    s_add_u32 s27, s27, 1
    s_cmp_lt_u32 s27, 18
    s_cbranch_scc1 k1loop_41
lw1_38:
    s_waitcnt lgkmcnt(0)
    s_nop 15
    s_nop 7
    v_cvt_pk_bf16_f32 v64, v128, v129
    v_cvt_pk_bf16_f32 v65, v130, v131
    v_cvt_pk_bf16_f32 v66, v132, v133
    v_cvt_pk_bf16_f32 v67, v134, v135
    v_cvt_pk_bf16_f32 v68, v136, v137
    v_cvt_pk_bf16_f32 v69, v138, v139
    v_cvt_pk_bf16_f32 v70, v140, v141
    v_cvt_pk_bf16_f32 v71, v142, v143
    v_bfe_u32 v100, v1, 4, 1
    v_mul_u32_u24 v100, 212992, v100
    v_and_b32 v101, 47, v1
    v_lshl_add_u32 v100, v101, 4, v100
    s_add_u32 s5, s31, 0
    s_add_u32 s5, s5, s39
    s_sub_u32 s5, s5, 32
    s_mul_i32 s5, s5, 425984
    s_add_u32 s4, s41, 0
    s_mul_i32 s4, s4, 3328
    s_add_u32 s4, s4, s5
    s_add_u32 s4, s4, 21234688
    buffer_store_dwordx4 v[64:67], v100, s[16:19], s4 offen sc0 sc1
    buffer_store_dwordx4 v[68:71], v100, s[16:19], s4 offen offset:1024 sc0 sc1
    s_nop 1
    v_cvt_pk_bf16_f32 v72, v144, v145
    v_cvt_pk_bf16_f32 v73, v146, v147
    v_cvt_pk_bf16_f32 v74, v148, v149
    v_cvt_pk_bf16_f32 v75, v150, v151
    v_cvt_pk_bf16_f32 v76, v152, v153
    v_cvt_pk_bf16_f32 v77, v154, v155
    v_cvt_pk_bf16_f32 v78, v156, v157
    v_cvt_pk_bf16_f32 v79, v158, v159
    v_bfe_u32 v100, v1, 4, 1
    v_mul_u32_u24 v100, 212992, v100
    v_and_b32 v101, 47, v1
    v_lshl_add_u32 v100, v101, 4, v100
    s_add_u32 s5, s31, 0
    s_add_u32 s5, s5, s39
    s_sub_u32 s5, s5, 32
    s_mul_i32 s5, s5, 425984
    s_add_u32 s4, s41, 1
    s_mul_i32 s4, s4, 3328
    s_add_u32 s4, s4, s5
    s_add_u32 s4, s4, 21234688
    buffer_store_dwordx4 v[72:75], v100, s[16:19], s4 offen sc0 sc1
    buffer_store_dwordx4 v[76:79], v100, s[16:19], s4 offen offset:1024 sc0 sc1
    s_nop 1
    v_cvt_pk_bf16_f32 v80, v160, v161
    v_cvt_pk_bf16_f32 v81, v162, v163
    v_cvt_pk_bf16_f32 v82, v164, v165
    v_cvt_pk_bf16_f32 v83, v166, v167
    v_cvt_pk_bf16_f32 v84, v168, v169
    v_cvt_pk_bf16_f32 v85, v170, v171
    v_cvt_pk_bf16_f32 v86, v172, v173
    v_cvt_pk_bf16_f32 v87, v174, v175
    v_bfe_u32 v100, v1, 4, 1
    v_mul_u32_u24 v100, 212992, v100
    v_and_b32 v101, 47, v1
    v_lshl_add_u32 v100, v101, 4, v100
    s_add_u32 s5, s31, 2
    s_add_u32 s5, s5, s39
    s_sub_u32 s5, s5, 32
    s_mul_i32 s5, s5, 425984
    s_add_u32 s4, s41, 0
    s_mul_i32 s4, s4, 3328
    s_add_u32 s4, s4, s5
    s_add_u32 s4, s4, 21234688
    buffer_store_dwordx4 v[80:83], v100, s[16:19], s4 offen sc0 sc1
    buffer_store_dwordx4 v[84:87], v100, s[16:19], s4 offen offset:1024 sc0 sc1
    s_nop 1
    v_cvt_pk_bf16_f32 v88, v176, v177
    v_cvt_pk_bf16_f32 v89, v178, v179
    v_cvt_pk_bf16_f32 v90, v180, v181
    v_cvt_pk_bf16_f32 v91, v182, v183
    v_cvt_pk_bf16_f32 v92, v184, v185
    v_cvt_pk_bf16_f32 v93, v186, v187
    v_cvt_pk_bf16_f32 v94, v188, v189
    v_cvt_pk_bf16_f32 v95, v190, v191
    v_bfe_u32 v100, v1, 4, 1
    v_mul_u32_u24 v100, 212992, v100
    v_and_b32 v101, 47, v1
    v_lshl_add_u32 v100, v101, 4, v100
    s_add_u32 s5, s31, 2
    s_add_u32 s5, s5, s39
    s_sub_u32 s5, s5, 32
    s_mul_i32 s5, s5, 425984
    s_add_u32 s4, s41, 1
    s_mul_i32 s4, s4, 3328
    s_add_u32 s4, s4, s5
    s_add_u32 s4, s4, 21234688
    buffer_store_dwordx4 v[88:91], v100, s[16:19], s4 offen sc0 sc1
    buffer_store_dwordx4 v[92:95], v100, s[16:19], s4 offen offset:1024 sc0 sc1
    s_nop 1
    v_cvt_pk_bf16_f32 v64, v192, v193
    v_cvt_pk_bf16_f32 v65, v194, v195
    v_cvt_pk_bf16_f32 v66, v196, v197
    v_cvt_pk_bf16_f32 v67, v198, v199
    v_cvt_pk_bf16_f32 v68, v200, v201
    v_cvt_pk_bf16_f32 v69, v202, v203
    v_cvt_pk_bf16_f32 v70, v204, v205
    v_cvt_pk_bf16_f32 v71, v206, v207
    v_bfe_u32 v100, v1, 4, 1
    v_mul_u32_u24 v100, 212992, v100
    v_and_b32 v101, 47, v1
    v_lshl_add_u32 v100, v101, 4, v100
    s_add_u32 s5, s31, 4
    s_add_u32 s5, s5, s39
    s_sub_u32 s5, s5, 32
    s_mul_i32 s5, s5, 425984
    s_add_u32 s4, s41, 0
    s_mul_i32 s4, s4, 3328
    s_add_u32 s4, s4, s5
    s_add_u32 s4, s4, 21234688
    buffer_store_dwordx4 v[64:67], v100, s[16:19], s4 offen sc0 sc1
    buffer_store_dwordx4 v[68:71], v100, s[16:19], s4 offen offset:1024 sc0 sc1
    s_nop 1
    v_cvt_pk_bf16_f32 v72, v208, v209
    v_cvt_pk_bf16_f32 v73, v210, v211
    v_cvt_pk_bf16_f32 v74, v212, v213
    v_cvt_pk_bf16_f32 v75, v214, v215
    v_cvt_pk_bf16_f32 v76, v216, v217
    v_cvt_pk_bf16_f32 v77, v218, v219
    v_cvt_pk_bf16_f32 v78, v220, v221
    v_cvt_pk_bf16_f32 v79, v222, v223
    v_bfe_u32 v100, v1, 4, 1
    v_mul_u32_u24 v100, 212992, v100
    v_and_b32 v101, 47, v1
    v_lshl_add_u32 v100, v101, 4, v100
    s_add_u32 s5, s31, 4
    s_add_u32 s5, s5, s39
    s_sub_u32 s5, s5, 32
    s_mul_i32 s5, s5, 425984
    s_add_u32 s4, s41, 1
    s_mul_i32 s4, s4, 3328
    s_add_u32 s4, s4, s5
    s_add_u32 s4, s4, 21234688
    buffer_store_dwordx4 v[72:75], v100, s[16:19], s4 offen sc0 sc1
    buffer_store_dwordx4 v[76:79], v100, s[16:19], s4 offen offset:1024 sc0 sc1
    s_nop 1
    v_cvt_pk_bf16_f32 v80, v224, v225
    v_cvt_pk_bf16_f32 v81, v226, v227
    v_cvt_pk_bf16_f32 v82, v228, v229
    v_cvt_pk_bf16_f32 v83, v230, v231
    v_cvt_pk_bf16_f32 v84, v232, v233
    v_cvt_pk_bf16_f32 v85, v234, v235
    v_cvt_pk_bf16_f32 v86, v236, v237
    v_cvt_pk_bf16_f32 v87, v238, v239
    v_bfe_u32 v100, v1, 1, 4
    v_mul_u32_u24 v100, 212992, v100
    v_and_b32 v101, 33, v1
    v_add_u32 v101, 16, v101
    v_lshl_add_u32 v100, v101, 4, v100
    s_sub_u32 s5, s36, 4
    s_mul_i32 s5, s5, 3407872
    s_mul_i32 s4, s32, 3328
    s_add_u32 s4, s4, s5
    s_add_u32 s4, s4, 21234688
    buffer_store_dwordx4 v[80:83], v100, s[16:19], s4 offen sc0 sc1
    buffer_store_dwordx4 v[84:87], v100, s[16:19], s4 offen offset:1024 sc0 sc1
    v_bfe_u32 v102, v1, 1, 4
    v_mul_u32_u24 v102, 212992, v102
    v_and_b32 v101, 32, v1
    v_add_u32 v101, 18, v101
    v_lshl_add_u32 v102, v101, 4, v102
    v_mov_b32 v104, 0x3f803f80
    v_mov_b32 v105, 0x3f803f80
    v_mov_b32 v106, 0x3f803f80
    v_mov_b32 v107, 0x3f803f80
    buffer_store_dwordx4 v[104:107], v102, s[16:19], s4 offen
    buffer_store_dwordx4 v[104:107], v102, s[16:19], s4 offen offset:1024
    s_nop 1
    s_endpgm
k1_end:
    s_endpgm
.text
.globl k2_kernel
.p2align 8
.type k2_kernel,@function
k2_kernel:
    s_cmp_ge_u32 s2, 505
    s_cbranch_scc1 k2_end
    v_lshrrev_b32 v2, 6, v0
    v_and_b32 v1, 63, v0
    s_nop 0
    v_readfirstlane_b32 s24, v2
    v_lshlrev_b32 v3, 4, v1
    s_load_dwordx2 s[16:17], s[0:1], 88
    s_mov_b32 s18, 42942464
    s_mov_b32 s19, 0x00020000
    s_waitcnt lgkmcnt(0)
    s_and_b32 s17, s17, 0xffff
    s_cmp_ge_u32 s2, 496
    s_cbranch_scc1 k2_prep
    s_cmp_ge_u32 s2, 256
    s_cbranch_scc1 k2_g2
    s_setprio 3
    s_and_b32 s4, s2, 7
    s_lshr_b32 s5, s2, 3
    s_lshl_b32 s4, s4, 2
    s_and_b32 s6, s5, 3
    s_add_u32 s25, s4, s6
    s_lshr_b32 s26, s5, 2
    s_lshl_b32 s27, s26, 3
    s_lshl_b32 s4, s24, 1
    s_add_u32 s27, s27, s4
    v_and_b32 v4, 31, v1
    v_lshlrev_b32 v4, 2, v4
    v_lshlrev_b32 v5, 2, v1
    s_lshl_b32 s4, s25, 16
    s_lshl_b32 s5, s27, 10
    s_add_u32 s4, s4, s5
    s_add_u32 s4, s4, 18874368
    s_lshl_b32 s6, s25, 13
    s_lshl_b32 s5, s27, 7
    s_add_u32 s6, s6, s5
    s_add_u32 s6, s6, 20971520
    buffer_load_dwordx4 v[156:159], v3, s[16:19], s4 offen offset:0
    buffer_load_dword v160, v4, s[16:19], s6 offen offset:0
    v_mov_b32 v161, 0
    v_mov_b32 v177, 0
    v_mov_b32 v162, 0
    v_mov_b32 v178, 0
    v_mov_b32 v163, 0
    v_mov_b32 v179, 0
    v_mov_b32 v124, 0
    v_mov_b32 v125, 0
    v_mov_b32 v126, 0
    v_mov_b32 v127, 0
    v_mov_b32 v128, 0
    v_mov_b32 v129, 0
    v_mov_b32 v130, 0
    v_mov_b32 v131, 0
    v_mov_b32 v132, 0
    v_mov_b32 v133, 0
    v_mov_b32 v134, 0
    v_mov_b32 v135, 0
    v_mov_b32 v136, 0
    v_mov_b32 v137, 0
    v_mov_b32 v138, 0
    v_mov_b32 v139, 0
    buffer_load_dwordx4 v[164:167], v3, s[16:19], s4 offen offset:1024
    buffer_load_dword v168, v4, s[16:19], s6 offen offset:128
    v_mov_b32 v169, 0
    v_mov_b32 v185, 0
    v_mov_b32 v170, 0
    v_mov_b32 v186, 0
    v_mov_b32 v171, 0
    v_mov_b32 v187, 0
    v_mov_b32 v140, 0
    v_mov_b32 v141, 0
    v_mov_b32 v142, 0
    v_mov_b32 v143, 0
    v_mov_b32 v144, 0
    v_mov_b32 v145, 0
    v_mov_b32 v146, 0
    v_mov_b32 v147, 0
    v_mov_b32 v148, 0
    v_mov_b32 v149, 0
    v_mov_b32 v150, 0
    v_mov_b32 v151, 0
    v_mov_b32 v152, 0
    v_mov_b32 v153, 0
    v_mov_b32 v154, 0
    v_mov_b32 v155, 0
    s_mul_i32 s28, s25, 212992
    s_mul_i32 s31, s24, 3328
    s_add_u32 s28, s28, s31
    s_add_u32 s28, s28, 21233664
    s_mov_b32 s44, 0
    s_mov_b32 s45, 0x07060302
att_pass:
    s_mov_b32 s33, s28
    s_add_u32 m0, s31, 0
    s_nop 0
    buffer_load_dwordx4 v3, s[16:19], s33 offen lds
    buffer_load_dwordx4 v3, s[16:19], s33 offen offset:1024 lds
    buffer_load_dwordx4 v3, s[16:19], s33 offen offset:2048 lds
    buffer_load_dword v4, s[16:19], s33 offen offset:3072 lds
    s_add_u32 s33, s33, 13312
    s_add_u32 m0, s31, 13312
    s_nop 0
    buffer_load_dwordx4 v3, s[16:19], s33 offen lds
    buffer_load_dwordx4 v3, s[16:19], s33 offen offset:1024 lds
    buffer_load_dwordx4 v3, s[16:19], s33 offen offset:2048 lds
    buffer_load_dword v4, s[16:19], s33 offen offset:3072 lds
    s_add_u32 s33, s33, 13312
    s_add_u32 m0, s31, 26624
    s_nop 0
    buffer_load_dwordx4 v3, s[16:19], s33 offen lds
    buffer_load_dwordx4 v3, s[16:19], s33 offen offset:1024 lds
    buffer_load_dwordx4 v3, s[16:19], s33 offen offset:2048 lds
    buffer_load_dword v4, s[16:19], s33 offen offset:3072 lds
    s_add_u32 s33, s33, 13312
    v_mov_b32 v76, 0
    v_mov_b32 v77, 0
    v_mov_b32 v78, 0
    v_mov_b32 v79, 0
    v_mov_b32 v80, 0
    v_mov_b32 v81, 0
    v_mov_b32 v82, 0
    v_mov_b32 v83, 0
    v_mov_b32 v84, 0
    v_mov_b32 v85, 0
    v_mov_b32 v86, 0
    v_mov_b32 v87, 0
    v_mov_b32 v88, 0
    v_mov_b32 v89, 0
    v_mov_b32 v90, 0
    v_mov_b32 v91, 0
    v_mov_b32 v108, 0
    v_mov_b32 v109, 0
    v_mov_b32 v110, 0
    v_mov_b32 v111, 0
    v_mov_b32 v112, 0
    v_mov_b32 v113, 0
    v_mov_b32 v114, 0
    v_mov_b32 v115, 0
    v_mov_b32 v92, 0
    v_mov_b32 v93, 0
    v_mov_b32 v94, 0
    v_mov_b32 v95, 0
    v_mov_b32 v96, 0
    v_mov_b32 v97, 0
    v_mov_b32 v98, 0
    v_mov_b32 v99, 0
    v_mov_b32 v100, 0
    v_mov_b32 v101, 0
    v_mov_b32 v102, 0
    v_mov_b32 v103, 0
    v_mov_b32 v104, 0
    v_mov_b32 v105, 0
    v_mov_b32 v106, 0
    v_mov_b32 v107, 0
    v_mov_b32 v116, 0
    v_mov_b32 v117, 0
    v_mov_b32 v118, 0
    v_mov_b32 v119, 0
    v_mov_b32 v120, 0
    v_mov_b32 v121, 0
    v_mov_b32 v122, 0
    v_mov_b32 v123, 0
    v_mov_b32 v196, 0
    v_mov_b32 v197, 0
    v_mov_b32 v198, 0
    v_mov_b32 v199, 0
    v_mov_b32 v200, 0
    v_mov_b32 v201, 0
    v_mov_b32 v202, 0
    v_mov_b32 v203, 0
    v_mov_b32 v72, 0
    v_mov_b32 v73, 0
    v_mov_b32 v74, 0
    v_mov_b32 v75, 0
    s_waitcnt vmcnt(8)
    s_barrier
    v_cmp_gt_u32 vcc, 32, v1
    v_cndmask_b32 v160, 0, v160, vcc
    v_cndmask_b32 v168, 0, v168, vcc
    ds_read_b128 v[172:175], v3 offset:0
    ds_read_b32 v176, v5 offset:3072
    ds_read_b128 v[180:183], v3 offset:3328
    ds_read_b32 v184, v5 offset:6400
    ds_read_b128 v[188:191], v3 offset:1024
    ds_read_b128 v[192:195], v3 offset:2048
    s_waitcnt lgkmcnt(0)
    v_mfma_f32_32x32x16_bf16 v[12:27], v[172:175], v[156:159], v[124:139]
    v_mfma_f32_32x32x16_bf16 v[28:43], v[172:175], v[164:167], v[140:155]
    v_mfma_f32_32x32x16_bf16 v[12:27], v[176:179], v[160:163], v[12:27]
    v_mfma_f32_32x32x16_bf16 v[28:43], v[176:179], v[168:171], v[28:43]
    s_nop 15
    s_mov_b32 s41, 0
att_loop:
    v_exp_f32 v12, v12
    v_perm_b32 v122, v73, v72, s45
    v_exp_f32 v13, v13
    v_perm_b32 v123, v75, v74, s45
    v_exp_f32 v14, v14
    v_mfma_f32_32x32x16_bf16 v[92:107], v[196:199], v[116:119], v[92:107]
    v_exp_f32 v15, v15
    ds_read_b128 v[172:175], v3 offset:6656
    v_exp_f32 v16, v16
    v_perm_b32 v108, v13, v12, s45
    v_exp_f32 v17, v17
    v_perm_b32 v109, v15, v14, s45
    v_exp_f32 v18, v18
    v_mfma_f32_32x32x16_bf16 v[92:107], v[200:203], v[120:123], v[92:107]
    v_exp_f32 v19, v19
    ds_read_b32 v176, v5 offset:9728
    ds_read_b128 v[196:199], v3 offset:4352
    v_exp_f32 v20, v20
    v_perm_b32 v110, v17, v16, s45
    v_exp_f32 v21, v21
    v_perm_b32 v111, v19, v18, s45
    v_exp_f32 v22, v22
    s_waitcnt lgkmcnt(3)
    v_mfma_f32_32x32x16_bf16 v[44:59], v[180:183], v[156:159], v[124:139]
    v_exp_f32 v23, v23
    ds_read_b128 v[200:203], v3 offset:5376
    v_exp_f32 v24, v24
    v_perm_b32 v112, v21, v20, s45
    v_exp_f32 v25, v25
    v_perm_b32 v113, v23, v22, s45
    v_exp_f32 v26, v26
    v_mfma_f32_32x32x16_bf16 v[60:75], v[180:183], v[164:167], v[140:155]
    v_exp_f32 v27, v27
    v_exp_f32 v28, v28
    v_perm_b32 v114, v25, v24, s45
    v_exp_f32 v29, v29
    v_perm_b32 v115, v27, v26, s45
    v_exp_f32 v30, v30
    v_mfma_f32_32x32x16_bf16 v[76:91], v[188:191], v[108:111], v[76:91]
    v_exp_f32 v31, v31
    v_exp_f32 v32, v32
    v_perm_b32 v116, v29, v28, s45
    v_exp_f32 v33, v33
    v_perm_b32 v117, v31, v30, s45
    v_exp_f32 v34, v34
    v_mfma_f32_32x32x16_bf16 v[44:59], v[184:187], v[160:163], v[44:59]
    v_exp_f32 v35, v35
    v_exp_f32 v36, v36
    v_perm_b32 v118, v33, v32, s45
    v_exp_f32 v37, v37
    v_perm_b32 v119, v35, v34, s45
    v_exp_f32 v38, v38
    v_mfma_f32_32x32x16_bf16 v[76:91], v[192:195], v[112:115], v[76:91]
    v_exp_f32 v39, v39
    v_exp_f32 v40, v40
    v_perm_b32 v120, v37, v36, s45
    v_exp_f32 v41, v41
    v_perm_b32 v121, v39, v38, s45
    v_exp_f32 v42, v42
    v_mfma_f32_32x32x16_bf16 v[60:75], v[184:187], v[168:171], v[60:75]
    v_exp_f32 v43, v43
    v_exp_f32 v44, v44
    v_perm_b32 v122, v41, v40, s45
    v_exp_f32 v45, v45
    v_perm_b32 v123, v43, v42, s45
    v_exp_f32 v46, v46
    v_mfma_f32_32x32x16_bf16 v[92:107], v[188:191], v[116:119], v[92:107]
    v_exp_f32 v47, v47
    ds_read_b128 v[180:183], v3 offset:9984
    v_exp_f32 v48, v48
    v_perm_b32 v108, v45, v44, s45
    v_exp_f32 v49, v49
    v_perm_b32 v109, v47, v46, s45
    v_exp_f32 v50, v50
    v_mfma_f32_32x32x16_bf16 v[92:107], v[192:195], v[120:123], v[92:107]
    v_exp_f32 v51, v51
    ds_read_b32 v184, v5 offset:13056
    ds_read_b128 v[188:191], v3 offset:7680
    v_exp_f32 v52, v52
    v_perm_b32 v110, v49, v48, s45
    v_exp_f32 v53, v53
    v_perm_b32 v111, v51, v50, s45
    v_exp_f32 v54, v54
    s_waitcnt lgkmcnt(3)
    v_mfma_f32_32x32x16_bf16 v[12:27], v[172:175], v[156:159], v[124:139]
    v_exp_f32 v55, v55
    ds_read_b128 v[192:195], v3 offset:8704
    v_exp_f32 v56, v56
    v_perm_b32 v112, v53, v52, s45
    v_exp_f32 v57, v57
    v_perm_b32 v113, v55, v54, s45
    v_exp_f32 v58, v58
    v_mfma_f32_32x32x16_bf16 v[28:43], v[172:175], v[164:167], v[140:155]
    v_exp_f32 v59, v59
    v_exp_f32 v60, v60
    v_perm_b32 v114, v57, v56, s45
    v_exp_f32 v61, v61
    v_perm_b32 v115, v59, v58, s45
    v_exp_f32 v62, v62
    v_mfma_f32_32x32x16_bf16 v[76:91], v[196:199], v[108:111], v[76:91]
    v_exp_f32 v63, v63
    v_exp_f32 v64, v64
    v_perm_b32 v116, v61, v60, s45
    v_exp_f32 v65, v65
    v_perm_b32 v117, v63, v62, s45
    v_exp_f32 v66, v66
    v_mfma_f32_32x32x16_bf16 v[12:27], v[176:179], v[160:163], v[12:27]
    v_exp_f32 v67, v67
    v_exp_f32 v68, v68
    v_perm_b32 v118, v65, v64, s45
    v_exp_f32 v69, v69
    v_perm_b32 v119, v67, v66, s45
    v_exp_f32 v70, v70
    v_mfma_f32_32x32x16_bf16 v[76:91], v[200:203], v[112:115], v[76:91]
    v_exp_f32 v71, v71
    v_exp_f32 v72, v72
    v_perm_b32 v120, v69, v68, s45
    v_exp_f32 v73, v73
    v_perm_b32 v121, v71, v70, s45
    v_exp_f32 v74, v74
    v_mfma_f32_32x32x16_bf16 v[28:43], v[176:179], v[168:171], v[28:43]
    v_exp_f32 v75, v75
    s_waitcnt vmcnt(4) lgkmcnt(0)
    s_barrier
    v_exp_f32 v12, v12
    v_perm_b32 v122, v73, v72, s45
    v_exp_f32 v13, v13
    v_perm_b32 v123, v75, v74, s45
    v_exp_f32 v14, v14
    v_mfma_f32_32x32x16_bf16 v[92:107], v[196:199], v[116:119], v[92:107]
    v_exp_f32 v15, v15
    ds_read_b128 v[172:175], v3 offset:13312
    v_exp_f32 v16, v16
    v_perm_b32 v108, v13, v12, s45
    v_exp_f32 v17, v17
    v_perm_b32 v109, v15, v14, s45
    v_exp_f32 v18, v18
    v_mfma_f32_32x32x16_bf16 v[92:107], v[200:203], v[120:123], v[92:107]
    v_exp_f32 v19, v19
    ds_read_b32 v176, v5 offset:16384
    ds_read_b128 v[196:199], v3 offset:11008
    v_exp_f32 v20, v20
    v_perm_b32 v110, v17, v16, s45
    v_exp_f32 v21, v21
    v_perm_b32 v111, v19, v18, s45
    v_exp_f32 v22, v22
    s_waitcnt lgkmcnt(3)
    v_mfma_f32_32x32x16_bf16 v[44:59], v[180:183], v[156:159], v[124:139]
    v_exp_f32 v23, v23
    ds_read_b128 v[200:203], v3 offset:12032
    s_add_u32 m0, s31, 39936
    v_exp_f32 v24, v24
    v_perm_b32 v112, v21, v20, s45
    v_exp_f32 v25, v25
    v_perm_b32 v113, v23, v22, s45
    v_exp_f32 v26, v26
    v_mfma_f32_32x32x16_bf16 v[60:75], v[180:183], v[164:167], v[140:155]
    v_exp_f32 v27, v27
    buffer_load_dwordx4 v3, s[16:19], s33 offen lds
    v_exp_f32 v28, v28
    v_perm_b32 v114, v25, v24, s45
    v_exp_f32 v29, v29
    v_perm_b32 v115, v27, v26, s45
    v_exp_f32 v30, v30
    v_mfma_f32_32x32x16_bf16 v[76:91], v[188:191], v[108:111], v[76:91]
    v_exp_f32 v31, v31
    buffer_load_dwordx4 v3, s[16:19], s33 offen offset:1024 lds
    v_exp_f32 v32, v32
    v_perm_b32 v116, v29, v28, s45
    v_exp_f32 v33, v33
    v_perm_b32 v117, v31, v30, s45
    v_exp_f32 v34, v34
    v_mfma_f32_32x32x16_bf16 v[44:59], v[184:187], v[160:163], v[44:59]
    v_exp_f32 v35, v35
    buffer_load_dwordx4 v3, s[16:19], s33 offen offset:2048 lds
    v_exp_f32 v36, v36
    v_perm_b32 v118, v33, v32, s45
    v_exp_f32 v37, v37
    v_perm_b32 v119, v35, v34, s45
    v_exp_f32 v38, v38
    v_mfma_f32_32x32x16_bf16 v[76:91], v[192:195], v[112:115], v[76:91]
    v_exp_f32 v39, v39
    buffer_load_dword v4, s[16:19], s33 offen offset:3072 lds
    v_exp_f32 v40, v40
    v_perm_b32 v120, v37, v36, s45
    v_exp_f32 v41, v41
    v_perm_b32 v121, v39, v38, s45
    v_exp_f32 v42, v42
    v_mfma_f32_32x32x16_bf16 v[60:75], v[184:187], v[168:171], v[60:75]
    v_exp_f32 v43, v43
    s_add_u32 s33, s33, 13312
    v_exp_f32 v44, v44
    v_perm_b32 v122, v41, v40, s45
    v_exp_f32 v45, v45
    v_perm_b32 v123, v43, v42, s45
    v_exp_f32 v46, v46
    v_mfma_f32_32x32x16_bf16 v[92:107], v[188:191], v[116:119], v[92:107]
    v_exp_f32 v47, v47
    ds_read_b128 v[180:183], v3 offset:16640
    v_exp_f32 v48, v48
    v_perm_b32 v108, v45, v44, s45
    v_exp_f32 v49, v49
    v_perm_b32 v109, v47, v46, s45
    v_exp_f32 v50, v50
    v_mfma_f32_32x32x16_bf16 v[92:107], v[192:195], v[120:123], v[92:107]
    v_exp_f32 v51, v51
    ds_read_b32 v184, v5 offset:19712
    ds_read_b128 v[188:191], v3 offset:14336
    v_exp_f32 v52, v52
    v_perm_b32 v110, v49, v48, s45
    v_exp_f32 v53, v53
    v_perm_b32 v111, v51, v50, s45
    v_exp_f32 v54, v54
    s_waitcnt lgkmcnt(3)
    v_mfma_f32_32x32x16_bf16 v[12:27], v[172:175], v[156:159], v[124:139]
    v_exp_f32 v55, v55
    ds_read_b128 v[192:195], v3 offset:15360
    v_exp_f32 v56, v56
    v_perm_b32 v112, v53, v52, s45
    v_exp_f32 v57, v57
    v_perm_b32 v113, v55, v54, s45
    v_exp_f32 v58, v58
    v_mfma_f32_32x32x16_bf16 v[28:43], v[172:175], v[164:167], v[140:155]
    v_exp_f32 v59, v59
    v_exp_f32 v60, v60
    v_perm_b32 v114, v57, v56, s45
    v_exp_f32 v61, v61
    v_perm_b32 v115, v59, v58, s45
    v_exp_f32 v62, v62
    v_mfma_f32_32x32x16_bf16 v[76:91], v[196:199], v[108:111], v[76:91]
    v_exp_f32 v63, v63
    v_exp_f32 v64, v64
    v_perm_b32 v116, v61, v60, s45
    v_exp_f32 v65, v65
    v_perm_b32 v117, v63, v62, s45
    v_exp_f32 v66, v66
    v_mfma_f32_32x32x16_bf16 v[12:27], v[176:179], v[160:163], v[12:27]
    v_exp_f32 v67, v67
    v_exp_f32 v68, v68
    v_perm_b32 v118, v65, v64, s45
    v_exp_f32 v69, v69
    v_perm_b32 v119, v67, v66, s45
    v_exp_f32 v70, v70
    v_mfma_f32_32x32x16_bf16 v[76:91], v[200:203], v[112:115], v[76:91]
    v_exp_f32 v71, v71
    v_exp_f32 v72, v72
    v_perm_b32 v120, v69, v68, s45
    v_exp_f32 v73, v73
    v_perm_b32 v121, v71, v70, s45
    v_exp_f32 v74, v74
    v_mfma_f32_32x32x16_bf16 v[28:43], v[176:179], v[168:171], v[28:43]
    v_exp_f32 v75, v75
    v_exp_f32 v12, v12
    v_perm_b32 v122, v73, v72, s45
    v_exp_f32 v13, v13
    v_perm_b32 v123, v75, v74, s45
    v_exp_f32 v14, v14
    v_mfma_f32_32x32x16_bf16 v[92:107], v[196:199], v[116:119], v[92:107]
    v_exp_f32 v15, v15
    ds_read_b128 v[172:175], v3 offset:19968
    v_exp_f32 v16, v16
    v_perm_b32 v108, v13, v12, s45
    v_exp_f32 v17, v17
    v_perm_b32 v109, v15, v14, s45
    v_exp_f32 v18, v18
    v_mfma_f32_32x32x16_bf16 v[92:107], v[200:203], v[120:123], v[92:107]
    v_exp_f32 v19, v19
    ds_read_b32 v176, v5 offset:23040
    ds_read_b128 v[196:199], v3 offset:17664
    v_exp_f32 v20, v20
    v_perm_b32 v110, v17, v16, s45
    v_exp_f32 v21, v21
    v_perm_b32 v111, v19, v18, s45
    v_exp_f32 v22, v22
    s_waitcnt lgkmcnt(3)
    v_mfma_f32_32x32x16_bf16 v[44:59], v[180:183], v[156:159], v[124:139]
    v_exp_f32 v23, v23
    ds_read_b128 v[200:203], v3 offset:18688
    v_exp_f32 v24, v24
    v_perm_b32 v112, v21, v20, s45
    v_exp_f32 v25, v25
    v_perm_b32 v113, v23, v22, s45
    v_exp_f32 v26, v26
    v_mfma_f32_32x32x16_bf16 v[60:75], v[180:183], v[164:167], v[140:155]
    v_exp_f32 v27, v27
    v_exp_f32 v28, v28
    v_perm_b32 v114, v25, v24, s45
    v_exp_f32 v29, v29
    v_perm_b32 v115, v27, v26, s45
    v_exp_f32 v30, v30
    v_mfma_f32_32x32x16_bf16 v[76:91], v[188:191], v[108:111], v[76:91]
    v_exp_f32 v31, v31
    v_exp_f32 v32, v32
    v_perm_b32 v116, v29, v28, s45
    v_exp_f32 v33, v33
    v_perm_b32 v117, v31, v30, s45
    v_exp_f32 v34, v34
    v_mfma_f32_32x32x16_bf16 v[44:59], v[184:187], v[160:163], v[44:59]
    v_exp_f32 v35, v35
    v_exp_f32 v36, v36
    v_perm_b32 v118, v33, v32, s45
    v_exp_f32 v37, v37
    v_perm_b32 v119, v35, v34, s45
    v_exp_f32 v38, v38
    v_mfma_f32_32x32x16_bf16 v[76:91], v[192:195], v[112:115], v[76:91]
    v_exp_f32 v39, v39
    v_exp_f32 v40, v40
    v_perm_b32 v120, v37, v36, s45
    v_exp_f32 v41, v41
    v_perm_b32 v121, v39, v38, s45
    v_exp_f32 v42, v42
    v_mfma_f32_32x32x16_bf16 v[60:75], v[184:187], v[168:171], v[60:75]
    v_exp_f32 v43, v43
    v_exp_f32 v44, v44
    v_perm_b32 v122, v41, v40, s45
    v_exp_f32 v45, v45
    v_perm_b32 v123, v43, v42, s45
    v_exp_f32 v46, v46
    v_mfma_f32_32x32x16_bf16 v[92:107], v[188:191], v[116:119], v[92:107]
    v_exp_f32 v47, v47
    ds_read_b128 v[180:183], v3 offset:23296
    v_exp_f32 v48, v48
    v_perm_b32 v108, v45, v44, s45
    v_exp_f32 v49, v49
    v_perm_b32 v109, v47, v46, s45
    v_exp_f32 v50, v50
    v_mfma_f32_32x32x16_bf16 v[92:107], v[192:195], v[120:123], v[92:107]
    v_exp_f32 v51, v51
    ds_read_b32 v184, v5 offset:26368
    ds_read_b128 v[188:191], v3 offset:20992
    v_exp_f32 v52, v52
    v_perm_b32 v110, v49, v48, s45
    v_exp_f32 v53, v53
    v_perm_b32 v111, v51, v50, s45
    v_exp_f32 v54, v54
    s_waitcnt lgkmcnt(3)
    v_mfma_f32_32x32x16_bf16 v[12:27], v[172:175], v[156:159], v[124:139]
    v_exp_f32 v55, v55
    ds_read_b128 v[192:195], v3 offset:22016
    v_exp_f32 v56, v56
    v_perm_b32 v112, v53, v52, s45
    v_exp_f32 v57, v57
    v_perm_b32 v113, v55, v54, s45
    v_exp_f32 v58, v58
    v_mfma_f32_32x32x16_bf16 v[28:43], v[172:175], v[164:167], v[140:155]
    v_exp_f32 v59, v59
    v_exp_f32 v60, v60
    v_perm_b32 v114, v57, v56, s45
    v_exp_f32 v61, v61
    v_perm_b32 v115, v59, v58, s45
    v_exp_f32 v62, v62
    v_mfma_f32_32x32x16_bf16 v[76:91], v[196:199], v[108:111], v[76:91]
    v_exp_f32 v63, v63
    v_exp_f32 v64, v64
    v_perm_b32 v116, v61, v60, s45
    v_exp_f32 v65, v65
    v_perm_b32 v117, v63, v62, s45
    v_exp_f32 v66, v66
    v_mfma_f32_32x32x16_bf16 v[12:27], v[176:179], v[160:163], v[12:27]
    v_exp_f32 v67, v67
    v_exp_f32 v68, v68
    v_perm_b32 v118, v65, v64, s45
    v_exp_f32 v69, v69
    v_perm_b32 v119, v67, v66, s45
    v_exp_f32 v70, v70
    v_mfma_f32_32x32x16_bf16 v[76:91], v[200:203], v[112:115], v[76:91]
    v_exp_f32 v71, v71
    v_exp_f32 v72, v72
    v_perm_b32 v120, v69, v68, s45
    v_exp_f32 v73, v73
    v_perm_b32 v121, v71, v70, s45
    v_exp_f32 v74, v74
    v_mfma_f32_32x32x16_bf16 v[28:43], v[176:179], v[168:171], v[28:43]
    v_exp_f32 v75, v75
    s_waitcnt vmcnt(4) lgkmcnt(0)
    s_barrier
    v_exp_f32 v12, v12
    v_perm_b32 v122, v73, v72, s45
    v_exp_f32 v13, v13
    v_perm_b32 v123, v75, v74, s45
    v_exp_f32 v14, v14
    v_mfma_f32_32x32x16_bf16 v[92:107], v[196:199], v[116:119], v[92:107]
    v_exp_f32 v15, v15
    ds_read_b128 v[172:175], v3 offset:26624
    v_exp_f32 v16, v16
    v_perm_b32 v108, v13, v12, s45
    v_exp_f32 v17, v17
    v_perm_b32 v109, v15, v14, s45
    v_exp_f32 v18, v18
    v_mfma_f32_32x32x16_bf16 v[92:107], v[200:203], v[120:123], v[92:107]
    v_exp_f32 v19, v19
    ds_read_b32 v176, v5 offset:29696
    ds_read_b128 v[196:199], v3 offset:24320
    v_exp_f32 v20, v20
    v_perm_b32 v110, v17, v16, s45
    v_exp_f32 v21, v21
    v_perm_b32 v111, v19, v18, s45
    v_exp_f32 v22, v22
    s_waitcnt lgkmcnt(3)
    v_mfma_f32_32x32x16_bf16 v[44:59], v[180:183], v[156:159], v[124:139]
    v_exp_f32 v23, v23
    ds_read_b128 v[200:203], v3 offset:25344
    s_add_u32 m0, s31, 0
    v_exp_f32 v24, v24
    v_perm_b32 v112, v21, v20, s45
    v_exp_f32 v25, v25
    v_perm_b32 v113, v23, v22, s45
    v_exp_f32 v26, v26
    v_mfma_f32_32x32x16_bf16 v[60:75], v[180:183], v[164:167], v[140:155]
    v_exp_f32 v27, v27
    buffer_load_dwordx4 v3, s[16:19], s33 offen lds
    v_exp_f32 v28, v28
    v_perm_b32 v114, v25, v24, s45
    v_exp_f32 v29, v29
    v_perm_b32 v115, v27, v26, s45
    v_exp_f32 v30, v30
    v_mfma_f32_32x32x16_bf16 v[76:91], v[188:191], v[108:111], v[76:91]
    v_exp_f32 v31, v31
    buffer_load_dwordx4 v3, s[16:19], s33 offen offset:1024 lds
    v_exp_f32 v32, v32
    v_perm_b32 v116, v29, v28, s45
    v_exp_f32 v33, v33
    v_perm_b32 v117, v31, v30, s45
    v_exp_f32 v34, v34
    v_mfma_f32_32x32x16_bf16 v[44:59], v[184:187], v[160:163], v[44:59]
    v_exp_f32 v35, v35
    buffer_load_dwordx4 v3, s[16:19], s33 offen offset:2048 lds
    v_exp_f32 v36, v36
    v_perm_b32 v118, v33, v32, s45
    v_exp_f32 v37, v37
    v_perm_b32 v119, v35, v34, s45
    v_exp_f32 v38, v38
    v_mfma_f32_32x32x16_bf16 v[76:91], v[192:195], v[112:115], v[76:91]
    v_exp_f32 v39, v39
    buffer_load_dword v4, s[16:19], s33 offen offset:3072 lds
    v_exp_f32 v40, v40
    v_perm_b32 v120, v37, v36, s45
    v_exp_f32 v41, v41
    v_perm_b32 v121, v39, v38, s45
    v_exp_f32 v42, v42
    v_mfma_f32_32x32x16_bf16 v[60:75], v[184:187], v[168:171], v[60:75]
    v_exp_f32 v43, v43
    s_add_u32 s33, s33, 13312
    v_exp_f32 v44, v44
    v_perm_b32 v122, v41, v40, s45
    v_exp_f32 v45, v45
    v_perm_b32 v123, v43, v42, s45
    v_exp_f32 v46, v46
    v_mfma_f32_32x32x16_bf16 v[92:107], v[188:191], v[116:119], v[92:107]
    v_exp_f32 v47, v47
    ds_read_b128 v[180:183], v3 offset:29952
    v_exp_f32 v48, v48
    v_perm_b32 v108, v45, v44, s45
    v_exp_f32 v49, v49
    v_perm_b32 v109, v47, v46, s45
    v_exp_f32 v50, v50
    v_mfma_f32_32x32x16_bf16 v[92:107], v[192:195], v[120:123], v[92:107]
    v_exp_f32 v51, v51
    ds_read_b32 v184, v5 offset:33024
    ds_read_b128 v[188:191], v3 offset:27648
    v_exp_f32 v52, v52
    v_perm_b32 v110, v49, v48, s45
    v_exp_f32 v53, v53
    v_perm_b32 v111, v51, v50, s45
    v_exp_f32 v54, v54
    s_waitcnt lgkmcnt(3)
    v_mfma_f32_32x32x16_bf16 v[12:27], v[172:175], v[156:159], v[124:139]
    v_exp_f32 v55, v55
    ds_read_b128 v[192:195], v3 offset:28672
    v_exp_f32 v56, v56
    v_perm_b32 v112, v53, v52, s45
    v_exp_f32 v57, v57
    v_perm_b32 v113, v55, v54, s45
    v_exp_f32 v58, v58
    v_mfma_f32_32x32x16_bf16 v[28:43], v[172:175], v[164:167], v[140:155]
    v_exp_f32 v59, v59
    v_exp_f32 v60, v60
    v_perm_b32 v114, v57, v56, s45
    v_exp_f32 v61, v61
    v_perm_b32 v115, v59, v58, s45
    v_exp_f32 v62, v62
    v_mfma_f32_32x32x16_bf16 v[76:91], v[196:199], v[108:111], v[76:91]
    v_exp_f32 v63, v63
    v_exp_f32 v64, v64
    v_perm_b32 v116, v61, v60, s45
    v_exp_f32 v65, v65
    v_perm_b32 v117, v63, v62, s45
    v_exp_f32 v66, v66
    v_mfma_f32_32x32x16_bf16 v[12:27], v[176:179], v[160:163], v[12:27]
    v_exp_f32 v67, v67
    v_exp_f32 v68, v68
    v_perm_b32 v118, v65, v64, s45
    v_exp_f32 v69, v69
    v_perm_b32 v119, v67, v66, s45
    v_exp_f32 v70, v70
    v_mfma_f32_32x32x16_bf16 v[76:91], v[200:203], v[112:115], v[76:91]
    v_exp_f32 v71, v71
    v_exp_f32 v72, v72
    v_perm_b32 v120, v69, v68, s45
    v_exp_f32 v73, v73
    v_perm_b32 v121, v71, v70, s45
    v_exp_f32 v74, v74
    v_mfma_f32_32x32x16_bf16 v[28:43], v[176:179], v[168:171], v[28:43]
    v_exp_f32 v75, v75
    v_exp_f32 v12, v12
    v_perm_b32 v122, v73, v72, s45
    v_exp_f32 v13, v13
    v_perm_b32 v123, v75, v74, s45
    v_exp_f32 v14, v14
    v_mfma_f32_32x32x16_bf16 v[92:107], v[196:199], v[116:119], v[92:107]
    v_exp_f32 v15, v15
    ds_read_b128 v[172:175], v3 offset:33280
    v_exp_f32 v16, v16
    v_perm_b32 v108, v13, v12, s45
    v_exp_f32 v17, v17
    v_perm_b32 v109, v15, v14, s45
    v_exp_f32 v18, v18
    v_mfma_f32_32x32x16_bf16 v[92:107], v[200:203], v[120:123], v[92:107]
    v_exp_f32 v19, v19
    ds_read_b32 v176, v5 offset:36352
    ds_read_b128 v[196:199], v3 offset:30976
    v_exp_f32 v20, v20
    v_perm_b32 v110, v17, v16, s45
    v_exp_f32 v21, v21
    v_perm_b32 v111, v19, v18, s45
    v_exp_f32 v22, v22
    s_waitcnt lgkmcnt(3)
    v_mfma_f32_32x32x16_bf16 v[44:59], v[180:183], v[156:159], v[124:139]
    v_exp_f32 v23, v23
    ds_read_b128 v[200:203], v3 offset:32000
    v_exp_f32 v24, v24
    v_perm_b32 v112, v21, v20, s45
    v_exp_f32 v25, v25
    v_perm_b32 v113, v23, v22, s45
    v_exp_f32 v26, v26
    v_mfma_f32_32x32x16_bf16 v[60:75], v[180:183], v[164:167], v[140:155]
    v_exp_f32 v27, v27
    v_exp_f32 v28, v28
    v_perm_b32 v114, v25, v24, s45
    v_exp_f32 v29, v29
    v_perm_b32 v115, v27, v26, s45
    v_exp_f32 v30, v30
    v_mfma_f32_32x32x16_bf16 v[76:91], v[188:191], v[108:111], v[76:91]
    v_exp_f32 v31, v31
    v_exp_f32 v32, v32
    v_perm_b32 v116, v29, v28, s45
    v_exp_f32 v33, v33
    v_perm_b32 v117, v31, v30, s45
    v_exp_f32 v34, v34
    v_mfma_f32_32x32x16_bf16 v[44:59], v[184:187], v[160:163], v[44:59]
    v_exp_f32 v35, v35
    v_exp_f32 v36, v36
    v_perm_b32 v118, v33, v32, s45
    v_exp_f32 v37, v37
    v_perm_b32 v119, v35, v34, s45
    v_exp_f32 v38, v38
    v_mfma_f32_32x32x16_bf16 v[76:91], v[192:195], v[112:115], v[76:91]
    v_exp_f32 v39, v39
    v_exp_f32 v40, v40
    v_perm_b32 v120, v37, v36, s45
    v_exp_f32 v41, v41
    v_perm_b32 v121, v39, v38, s45
    v_exp_f32 v42, v42
    v_mfma_f32_32x32x16_bf16 v[60:75], v[184:187], v[168:171], v[60:75]
    v_exp_f32 v43, v43
    v_exp_f32 v44, v44
    v_perm_b32 v122, v41, v40, s45
    v_exp_f32 v45, v45
    v_perm_b32 v123, v43, v42, s45
    v_exp_f32 v46, v46
    v_mfma_f32_32x32x16_bf16 v[92:107], v[188:191], v[116:119], v[92:107]
    v_exp_f32 v47, v47
    ds_read_b128 v[180:183], v3 offset:36608
    v_exp_f32 v48, v48
    v_perm_b32 v108, v45, v44, s45
    v_exp_f32 v49, v49
    v_perm_b32 v109, v47, v46, s45
    v_exp_f32 v50, v50
    v_mfma_f32_32x32x16_bf16 v[92:107], v[192:195], v[120:123], v[92:107]
    v_exp_f32 v51, v51
    ds_read_b32 v184, v5 offset:39680
    ds_read_b128 v[188:191], v3 offset:34304
    v_exp_f32 v52, v52
    v_perm_b32 v110, v49, v48, s45
    v_exp_f32 v53, v53
    v_perm_b32 v111, v51, v50, s45
    v_exp_f32 v54, v54
    s_waitcnt lgkmcnt(3)
    v_mfma_f32_32x32x16_bf16 v[12:27], v[172:175], v[156:159], v[124:139]
    v_exp_f32 v55, v55
    ds_read_b128 v[192:195], v3 offset:35328
    v_exp_f32 v56, v56
    v_perm_b32 v112, v53, v52, s45
    v_exp_f32 v57, v57
    v_perm_b32 v113, v55, v54, s45
    v_exp_f32 v58, v58
    v_mfma_f32_32x32x16_bf16 v[28:43], v[172:175], v[164:167], v[140:155]
    v_exp_f32 v59, v59
    v_exp_f32 v60, v60
    v_perm_b32 v114, v57, v56, s45
    v_exp_f32 v61, v61
    v_perm_b32 v115, v59, v58, s45
    v_exp_f32 v62, v62
    v_mfma_f32_32x32x16_bf16 v[76:91], v[196:199], v[108:111], v[76:91]
    v_exp_f32 v63, v63
    v_exp_f32 v64, v64
    v_perm_b32 v116, v61, v60, s45
    v_exp_f32 v65, v65
    v_perm_b32 v117, v63, v62, s45
    v_exp_f32 v66, v66
    v_mfma_f32_32x32x16_bf16 v[12:27], v[176:179], v[160:163], v[12:27]
    v_exp_f32 v67, v67
    v_exp_f32 v68, v68
    v_perm_b32 v118, v65, v64, s45
    v_exp_f32 v69, v69
    v_perm_b32 v119, v67, v66, s45
    v_exp_f32 v70, v70
    v_mfma_f32_32x32x16_bf16 v[76:91], v[200:203], v[112:115], v[76:91]
    v_exp_f32 v71, v71
    v_exp_f32 v72, v72
    v_perm_b32 v120, v69, v68, s45
    v_exp_f32 v73, v73
    v_perm_b32 v121, v71, v70, s45
    v_exp_f32 v74, v74
    v_mfma_f32_32x32x16_bf16 v[28:43], v[176:179], v[168:171], v[28:43]
    v_exp_f32 v75, v75
    s_waitcnt vmcnt(4) lgkmcnt(0)
    s_barrier
    v_exp_f32 v12, v12
    v_perm_b32 v122, v73, v72, s45
    v_exp_f32 v13, v13
    v_perm_b32 v123, v75, v74, s45
    v_exp_f32 v14, v14
    v_mfma_f32_32x32x16_bf16 v[92:107], v[196:199], v[116:119], v[92:107]
    v_exp_f32 v15, v15
    ds_read_b128 v[172:175], v3 offset:39936
    v_exp_f32 v16, v16
    v_perm_b32 v108, v13, v12, s45
    v_exp_f32 v17, v17
    v_perm_b32 v109, v15, v14, s45
    v_exp_f32 v18, v18
    v_mfma_f32_32x32x16_bf16 v[92:107], v[200:203], v[120:123], v[92:107]
    v_exp_f32 v19, v19
    ds_read_b32 v176, v5 offset:43008
    ds_read_b128 v[196:199], v3 offset:37632
    v_exp_f32 v20, v20
    v_perm_b32 v110, v17, v16, s45
    v_exp_f32 v21, v21
    v_perm_b32 v111, v19, v18, s45
    v_exp_f32 v22, v22
    s_waitcnt lgkmcnt(3)
    v_mfma_f32_32x32x16_bf16 v[44:59], v[180:183], v[156:159], v[124:139]
    v_exp_f32 v23, v23
    ds_read_b128 v[200:203], v3 offset:38656
    s_add_u32 m0, s31, 13312
    v_exp_f32 v24, v24
    v_perm_b32 v112, v21, v20, s45
    v_exp_f32 v25, v25
    v_perm_b32 v113, v23, v22, s45
    v_exp_f32 v26, v26
    v_mfma_f32_32x32x16_bf16 v[60:75], v[180:183], v[164:167], v[140:155]
    v_exp_f32 v27, v27
    buffer_load_dwordx4 v3, s[16:19], s33 offen lds
    v_exp_f32 v28, v28
    v_perm_b32 v114, v25, v24, s45
    v_exp_f32 v29, v29
    v_perm_b32 v115, v27, v26, s45
    v_exp_f32 v30, v30
    v_mfma_f32_32x32x16_bf16 v[76:91], v[188:191], v[108:111], v[76:91]
    v_exp_f32 v31, v31
    buffer_load_dwordx4 v3, s[16:19], s33 offen offset:1024 lds
    v_exp_f32 v32, v32
    v_perm_b32 v116, v29, v28, s45
    v_exp_f32 v33, v33
    v_perm_b32 v117, v31, v30, s45
    v_exp_f32 v34, v34
    v_mfma_f32_32x32x16_bf16 v[44:59], v[184:187], v[160:163], v[44:59]
    v_exp_f32 v35, v35
    buffer_load_dwordx4 v3, s[16:19], s33 offen offset:2048 lds
    v_exp_f32 v36, v36
    v_perm_b32 v118, v33, v32, s45
    v_exp_f32 v37, v37
    v_perm_b32 v119, v35, v34, s45
    v_exp_f32 v38, v38
    v_mfma_f32_32x32x16_bf16 v[76:91], v[192:195], v[112:115], v[76:91]
    v_exp_f32 v39, v39
    buffer_load_dword v4, s[16:19], s33 offen offset:3072 lds
    v_exp_f32 v40, v40
    v_perm_b32 v120, v37, v36, s45
    v_exp_f32 v41, v41
    v_perm_b32 v121, v39, v38, s45
    v_exp_f32 v42, v42
    v_mfma_f32_32x32x16_bf16 v[60:75], v[184:187], v[168:171], v[60:75]
    v_exp_f32 v43, v43
    s_add_u32 s33, s33, 13312
    v_exp_f32 v44, v44
    v_perm_b32 v122, v41, v40, s45
    v_exp_f32 v45, v45
    v_perm_b32 v123, v43, v42, s45
    v_exp_f32 v46, v46
    v_mfma_f32_32x32x16_bf16 v[92:107], v[188:191], v[116:119], v[92:107]
    v_exp_f32 v47, v47
    ds_read_b128 v[180:183], v3 offset:43264
    v_exp_f32 v48, v48
    v_perm_b32 v108, v45, v44, s45
    v_exp_f32 v49, v49
    v_perm_b32 v109, v47, v46, s45
    v_exp_f32 v50, v50
    v_mfma_f32_32x32x16_bf16 v[92:107], v[192:195], v[120:123], v[92:107]
    v_exp_f32 v51, v51
    ds_read_b32 v184, v5 offset:46336
    ds_read_b128 v[188:191], v3 offset:40960
    v_exp_f32 v52, v52
    v_perm_b32 v110, v49, v48, s45
    v_exp_f32 v53, v53
    v_perm_b32 v111, v51, v50, s45
    v_exp_f32 v54, v54
    s_waitcnt lgkmcnt(3)
    v_mfma_f32_32x32x16_bf16 v[12:27], v[172:175], v[156:159], v[124:139]
    v_exp_f32 v55, v55
    ds_read_b128 v[192:195], v3 offset:41984
    v_exp_f32 v56, v56
    v_perm_b32 v112, v53, v52, s45
    v_exp_f32 v57, v57
    v_perm_b32 v113, v55, v54, s45
    v_exp_f32 v58, v58
    v_mfma_f32_32x32x16_bf16 v[28:43], v[172:175], v[164:167], v[140:155]
    v_exp_f32 v59, v59
    v_exp_f32 v60, v60
    v_perm_b32 v114, v57, v56, s45
    v_exp_f32 v61, v61
    v_perm_b32 v115, v59, v58, s45
    v_exp_f32 v62, v62
    v_mfma_f32_32x32x16_bf16 v[76:91], v[196:199], v[108:111], v[76:91]
    v_exp_f32 v63, v63
    v_exp_f32 v64, v64
    v_perm_b32 v116, v61, v60, s45
    v_exp_f32 v65, v65
    v_perm_b32 v117, v63, v62, s45
    v_exp_f32 v66, v66
    v_mfma_f32_32x32x16_bf16 v[12:27], v[176:179], v[160:163], v[12:27]
    v_exp_f32 v67, v67
    v_exp_f32 v68, v68
    v_perm_b32 v118, v65, v64, s45
    v_exp_f32 v69, v69
    v_perm_b32 v119, v67, v66, s45
    v_exp_f32 v70, v70
    v_mfma_f32_32x32x16_bf16 v[76:91], v[200:203], v[112:115], v[76:91]
    v_exp_f32 v71, v71
    v_exp_f32 v72, v72
    v_perm_b32 v120, v69, v68, s45
    v_exp_f32 v73, v73
    v_perm_b32 v121, v71, v70, s45
    v_exp_f32 v74, v74
    v_mfma_f32_32x32x16_bf16 v[28:43], v[176:179], v[168:171], v[28:43]
    v_exp_f32 v75, v75
    v_exp_f32 v12, v12
    v_perm_b32 v122, v73, v72, s45
    v_exp_f32 v13, v13
    v_perm_b32 v123, v75, v74, s45
    v_exp_f32 v14, v14
    v_mfma_f32_32x32x16_bf16 v[92:107], v[196:199], v[116:119], v[92:107]
    v_exp_f32 v15, v15
    ds_read_b128 v[172:175], v3 offset:46592
    v_exp_f32 v16, v16
    v_perm_b32 v108, v13, v12, s45
    v_exp_f32 v17, v17
    v_perm_b32 v109, v15, v14, s45
    v_exp_f32 v18, v18
    v_mfma_f32_32x32x16_bf16 v[92:107], v[200:203], v[120:123], v[92:107]
    v_exp_f32 v19, v19
    ds_read_b32 v176, v5 offset:49664
    ds_read_b128 v[196:199], v3 offset:44288
    v_exp_f32 v20, v20
    v_perm_b32 v110, v17, v16, s45
    v_exp_f32 v21, v21
    v_perm_b32 v111, v19, v18, s45
    v_exp_f32 v22, v22
    s_waitcnt lgkmcnt(3)
    v_mfma_f32_32x32x16_bf16 v[44:59], v[180:183], v[156:159], v[124:139]
    v_exp_f32 v23, v23
    ds_read_b128 v[200:203], v3 offset:45312
    v_exp_f32 v24, v24
    v_perm_b32 v112, v21, v20, s45
    v_exp_f32 v25, v25
    v_perm_b32 v113, v23, v22, s45
    v_exp_f32 v26, v26
    v_mfma_f32_32x32x16_bf16 v[60:75], v[180:183], v[164:167], v[140:155]
    v_exp_f32 v27, v27
    v_exp_f32 v28, v28
    v_perm_b32 v114, v25, v24, s45
    v_exp_f32 v29, v29
    v_perm_b32 v115, v27, v26, s45
    v_exp_f32 v30, v30
    v_mfma_f32_32x32x16_bf16 v[76:91], v[188:191], v[108:111], v[76:91]
    v_exp_f32 v31, v31
    v_exp_f32 v32, v32
    v_perm_b32 v116, v29, v28, s45
    v_exp_f32 v33, v33
    v_perm_b32 v117, v31, v30, s45
    v_exp_f32 v34, v34
    v_mfma_f32_32x32x16_bf16 v[44:59], v[184:187], v[160:163], v[44:59]
    v_exp_f32 v35, v35
    v_exp_f32 v36, v36
    v_perm_b32 v118, v33, v32, s45
    v_exp_f32 v37, v37
    v_perm_b32 v119, v35, v34, s45
    v_exp_f32 v38, v38
    v_mfma_f32_32x32x16_bf16 v[76:91], v[192:195], v[112:115], v[76:91]
    v_exp_f32 v39, v39
    v_exp_f32 v40, v40
    v_perm_b32 v120, v37, v36, s45
    v_exp_f32 v41, v41
    v_perm_b32 v121, v39, v38, s45
    v_exp_f32 v42, v42
    v_mfma_f32_32x32x16_bf16 v[60:75], v[184:187], v[168:171], v[60:75]
    v_exp_f32 v43, v43
    v_exp_f32 v44, v44
    v_perm_b32 v122, v41, v40, s45
    v_exp_f32 v45, v45
    v_perm_b32 v123, v43, v42, s45
    v_exp_f32 v46, v46
    v_mfma_f32_32x32x16_bf16 v[92:107], v[188:191], v[116:119], v[92:107]
    v_exp_f32 v47, v47
    ds_read_b128 v[180:183], v3 offset:49920
    v_exp_f32 v48, v48
    v_perm_b32 v108, v45, v44, s45
    v_exp_f32 v49, v49
    v_perm_b32 v109, v47, v46, s45
    v_exp_f32 v50, v50
    v_mfma_f32_32x32x16_bf16 v[92:107], v[192:195], v[120:123], v[92:107]
    v_exp_f32 v51, v51
    ds_read_b32 v184, v5 offset:52992
    ds_read_b128 v[188:191], v3 offset:47616
    v_exp_f32 v52, v52
    v_perm_b32 v110, v49, v48, s45
    v_exp_f32 v53, v53
    v_perm_b32 v111, v51, v50, s45
    v_exp_f32 v54, v54
    s_waitcnt lgkmcnt(3)
    v_mfma_f32_32x32x16_bf16 v[12:27], v[172:175], v[156:159], v[124:139]
    v_exp_f32 v55, v55
    ds_read_b128 v[192:195], v3 offset:48640
    v_exp_f32 v56, v56
    v_perm_b32 v112, v53, v52, s45
    v_exp_f32 v57, v57
    v_perm_b32 v113, v55, v54, s45
    v_exp_f32 v58, v58
    v_mfma_f32_32x32x16_bf16 v[28:43], v[172:175], v[164:167], v[140:155]
    v_exp_f32 v59, v59
    v_exp_f32 v60, v60
    v_perm_b32 v114, v57, v56, s45
    v_exp_f32 v61, v61
    v_perm_b32 v115, v59, v58, s45
    v_exp_f32 v62, v62
    v_mfma_f32_32x32x16_bf16 v[76:91], v[196:199], v[108:111], v[76:91]
    v_exp_f32 v63, v63
    v_exp_f32 v64, v64
    v_perm_b32 v116, v61, v60, s45
    v_exp_f32 v65, v65
    v_perm_b32 v117, v63, v62, s45
    v_exp_f32 v66, v66
    v_mfma_f32_32x32x16_bf16 v[12:27], v[176:179], v[160:163], v[12:27]
    v_exp_f32 v67, v67
    v_exp_f32 v68, v68
    v_perm_b32 v118, v65, v64, s45
    v_exp_f32 v69, v69
    v_perm_b32 v119, v67, v66, s45
    v_exp_f32 v70, v70
    v_mfma_f32_32x32x16_bf16 v[76:91], v[200:203], v[112:115], v[76:91]
    v_exp_f32 v71, v71
    v_exp_f32 v72, v72
    v_perm_b32 v120, v69, v68, s45
    v_exp_f32 v73, v73
    v_perm_b32 v121, v71, v70, s45
    v_exp_f32 v74, v74
    v_mfma_f32_32x32x16_bf16 v[28:43], v[176:179], v[168:171], v[28:43]
    v_exp_f32 v75, v75
    s_waitcnt vmcnt(4) lgkmcnt(0)
    s_barrier
    v_exp_f32 v12, v12
    v_perm_b32 v122, v73, v72, s45
    v_exp_f32 v13, v13
    v_perm_b32 v123, v75, v74, s45
    v_exp_f32 v14, v14
    v_mfma_f32_32x32x16_bf16 v[92:107], v[196:199], v[116:119], v[92:107]
    v_exp_f32 v15, v15
    ds_read_b128 v[172:175], v3 offset:0
    v_exp_f32 v16, v16
    v_perm_b32 v108, v13, v12, s45
    v_exp_f32 v17, v17
    v_perm_b32 v109, v15, v14, s45
    v_exp_f32 v18, v18
    v_mfma_f32_32x32x16_bf16 v[92:107], v[200:203], v[120:123], v[92:107]
    v_exp_f32 v19, v19
    ds_read_b32 v176, v5 offset:3072
    ds_read_b128 v[196:199], v3 offset:50944
    v_exp_f32 v20, v20
    v_perm_b32 v110, v17, v16, s45
    v_exp_f32 v21, v21
    v_perm_b32 v111, v19, v18, s45
    v_exp_f32 v22, v22
    s_waitcnt lgkmcnt(3)
    v_mfma_f32_32x32x16_bf16 v[44:59], v[180:183], v[156:159], v[124:139]
    v_exp_f32 v23, v23
    ds_read_b128 v[200:203], v3 offset:51968
    s_add_u32 m0, s31, 26624
    v_exp_f32 v24, v24
    v_perm_b32 v112, v21, v20, s45
    v_exp_f32 v25, v25
    v_perm_b32 v113, v23, v22, s45
    v_exp_f32 v26, v26
    v_mfma_f32_32x32x16_bf16 v[60:75], v[180:183], v[164:167], v[140:155]
    v_exp_f32 v27, v27
    buffer_load_dwordx4 v3, s[16:19], s33 offen lds
    v_exp_f32 v28, v28
    v_perm_b32 v114, v25, v24, s45
    v_exp_f32 v29, v29
    v_perm_b32 v115, v27, v26, s45
    v_exp_f32 v30, v30
    v_mfma_f32_32x32x16_bf16 v[76:91], v[188:191], v[108:111], v[76:91]
    v_exp_f32 v31, v31
    buffer_load_dwordx4 v3, s[16:19], s33 offen offset:1024 lds
    v_exp_f32 v32, v32
    v_perm_b32 v116, v29, v28, s45
    v_exp_f32 v33, v33
    v_perm_b32 v117, v31, v30, s45
    v_exp_f32 v34, v34
    v_mfma_f32_32x32x16_bf16 v[44:59], v[184:187], v[160:163], v[44:59]
    v_exp_f32 v35, v35
    buffer_load_dwordx4 v3, s[16:19], s33 offen offset:2048 lds
    v_exp_f32 v36, v36
    v_perm_b32 v118, v33, v32, s45
    v_exp_f32 v37, v37
    v_perm_b32 v119, v35, v34, s45
    v_exp_f32 v38, v38
    v_mfma_f32_32x32x16_bf16 v[76:91], v[192:195], v[112:115], v[76:91]
    v_exp_f32 v39, v39
    buffer_load_dword v4, s[16:19], s33 offen offset:3072 lds
    v_exp_f32 v40, v40
    v_perm_b32 v120, v37, v36, s45
    v_exp_f32 v41, v41
    v_perm_b32 v121, v39, v38, s45
    v_exp_f32 v42, v42
    v_mfma_f32_32x32x16_bf16 v[60:75], v[184:187], v[168:171], v[60:75]
    v_exp_f32 v43, v43
    s_add_u32 s33, s33, 13312
    v_exp_f32 v44, v44
    v_perm_b32 v122, v41, v40, s45
    v_exp_f32 v45, v45
    v_perm_b32 v123, v43, v42, s45
    v_exp_f32 v46, v46
    v_mfma_f32_32x32x16_bf16 v[92:107], v[188:191], v[116:119], v[92:107]
    v_exp_f32 v47, v47
    ds_read_b128 v[180:183], v3 offset:3328
    v_exp_f32 v48, v48
    v_perm_b32 v108, v45, v44, s45
    v_exp_f32 v49, v49
    v_perm_b32 v109, v47, v46, s45
    v_exp_f32 v50, v50
    v_mfma_f32_32x32x16_bf16 v[92:107], v[192:195], v[120:123], v[92:107]
    v_exp_f32 v51, v51
    ds_read_b32 v184, v5 offset:6400
    ds_read_b128 v[188:191], v3 offset:1024
    v_exp_f32 v52, v52
    v_perm_b32 v110, v49, v48, s45
    v_exp_f32 v53, v53
    v_perm_b32 v111, v51, v50, s45
    v_exp_f32 v54, v54
    s_waitcnt lgkmcnt(3)
    v_mfma_f32_32x32x16_bf16 v[12:27], v[172:175], v[156:159], v[124:139]
    v_exp_f32 v55, v55
    ds_read_b128 v[192:195], v3 offset:2048
    v_exp_f32 v56, v56
    v_perm_b32 v112, v53, v52, s45
    v_exp_f32 v57, v57
    v_perm_b32 v113, v55, v54, s45
    v_exp_f32 v58, v58
    v_mfma_f32_32x32x16_bf16 v[28:43], v[172:175], v[164:167], v[140:155]
    v_exp_f32 v59, v59
    v_exp_f32 v60, v60
    v_perm_b32 v114, v57, v56, s45
    v_exp_f32 v61, v61
    v_perm_b32 v115, v59, v58, s45
    v_exp_f32 v62, v62
    v_mfma_f32_32x32x16_bf16 v[76:91], v[196:199], v[108:111], v[76:91]
    v_exp_f32 v63, v63
    v_exp_f32 v64, v64
    v_perm_b32 v116, v61, v60, s45
    v_exp_f32 v65, v65
    v_perm_b32 v117, v63, v62, s45
    v_exp_f32 v66, v66
    v_mfma_f32_32x32x16_bf16 v[12:27], v[176:179], v[160:163], v[12:27]
    v_exp_f32 v67, v67
    v_exp_f32 v68, v68
    v_perm_b32 v118, v65, v64, s45
    v_exp_f32 v69, v69
    v_perm_b32 v119, v67, v66, s45
    v_exp_f32 v70, v70
    v_mfma_f32_32x32x16_bf16 v[76:91], v[200:203], v[112:115], v[76:91]
    v_exp_f32 v71, v71
    v_exp_f32 v72, v72
    v_perm_b32 v120, v69, v68, s45
    v_exp_f32 v73, v73
    v_perm_b32 v121, v71, v70, s45
    v_exp_f32 v74, v74
    v_mfma_f32_32x32x16_bf16 v[28:43], v[176:179], v[168:171], v[28:43]
    v_exp_f32 v75, v75
    s_add_u32 s41, s41, 1
    s_cmp_lt_u32 s41, 4
    s_cbranch_scc1 att_loop
    s_nop 0
    v_perm_b32 v122, v73, v72, s45
    v_perm_b32 v123, v75, v74, s45
    s_nop 1
    v_mfma_f32_32x32x16_bf16 v[92:107], v[196:199], v[116:119], v[92:107]
    v_mfma_f32_32x32x16_bf16 v[92:107], v[200:203], v[120:123], v[92:107]
    s_waitcnt vmcnt(0) lgkmcnt(0)
    s_nop 15
    s_nop 7
    s_cmp_lg_u32 s44, 0
    s_cbranch_scc1 att_fin
    v_mul_f32 v204, 0, v76
    v_mul_f32 v206, 0, v92
    v_fma_f32 v204, v77, 0, v204
    v_fma_f32 v206, v93, 0, v206
    v_fma_f32 v204, v78, 0, v204
    v_fma_f32 v206, v94, 0, v206
    v_fma_f32 v204, v79, 0, v204
    v_fma_f32 v206, v95, 0, v206
    v_fma_f32 v204, v80, 0, v204
    v_fma_f32 v206, v96, 0, v206
    v_fma_f32 v204, v81, 0, v204
    v_fma_f32 v206, v97, 0, v206
    v_fma_f32 v204, v82, 0, v204
    v_fma_f32 v206, v98, 0, v206
    v_fma_f32 v204, v83, 0, v204
    v_fma_f32 v206, v99, 0, v206
    v_mul_f32 v205, 0, v84
    v_mul_f32 v207, 0, v100
    v_fma_f32 v205, v85, 0, v205
    v_fma_f32 v207, v101, 0, v207
    v_add_f32 v204, v204, v206
    v_add_f32 v205, v205, v207
    v_mov_b32 v206, 0x21800000
    v_mov_b32 v207, 0x5d800000
    v_cmp_nle_f32 s[46:47], v206, v86
    v_cmp_nle_f32 s[48:49], v206, v102
    v_cmp_nge_f32 s[50:51], v207, v86
    v_cmp_nge_f32 s[52:53], v207, v102
    v_cmp_u_f32 s[54:55], v205, v205
    v_cmp_u_f32 vcc, v204, v204
    s_nop 4
    s_or_b32 s46, s46, s48
    s_or_b32 s50, s50, s52
    s_or_b32 s46, s46, s54
    s_or_b32 s46, s46, s50
    s_mov_b32 s47, 0
    s_or_b64 s[46:47], s[46:47], vcc
    s_cmp_lg_u64 s[46:47], 0
    s_cselect_b32 s4, 1, 0
    v_mov_b32 v204, s4
    s_lshl_b32 s5, s24, 2
    s_add_u32 s5, s5, 53248
    v_mov_b32 v205, s5
    ds_write_b32 v205, v204
    s_waitcnt lgkmcnt(0)
    s_barrier
    v_mov_b32 v205, 53248
    ds_read_b128 v[208:211], v205
    s_waitcnt lgkmcnt(0)
    v_or_b32 v208, v208, v209
    v_or_b32 v210, v210, v211
    v_or_b32 v208, v208, v210
    s_nop 1
    v_readfirstlane_b32 s4, v208
    s_cmp_eq_u32 s4, 0
    s_cbranch_scc1 att_fin
    s_mov_b32 s44, 1
    v_mov_b32 v124, 0xff800000
    v_mov_b32 v125, 0xff800000
    v_mov_b32 v126, 0xff800000
    v_mov_b32 v127, 0xff800000
    v_mov_b32 v128, 0xff800000
    v_mov_b32 v129, 0xff800000
    v_mov_b32 v130, 0xff800000
    v_mov_b32 v131, 0xff800000
    v_mov_b32 v132, 0xff800000
    v_mov_b32 v133, 0xff800000
    v_mov_b32 v134, 0xff800000
    v_mov_b32 v135, 0xff800000
    v_mov_b32 v136, 0xff800000
    v_mov_b32 v137, 0xff800000
    v_mov_b32 v138, 0xff800000
    v_mov_b32 v139, 0xff800000
    v_mov_b32 v140, 0xff800000
    v_mov_b32 v141, 0xff800000
    v_mov_b32 v142, 0xff800000
    v_mov_b32 v143, 0xff800000
    v_mov_b32 v144, 0xff800000
    v_mov_b32 v145, 0xff800000
    v_mov_b32 v146, 0xff800000
    v_mov_b32 v147, 0xff800000
    v_mov_b32 v148, 0xff800000
    v_mov_b32 v149, 0xff800000
    v_mov_b32 v150, 0xff800000
    v_mov_b32 v151, 0xff800000
    v_mov_b32 v152, 0xff800000
    v_mov_b32 v153, 0xff800000
    v_mov_b32 v154, 0xff800000
    v_mov_b32 v155, 0xff800000
    s_mul_i32 s33, s25, 212992
    s_add_u32 s33, s33, 21233664
    s_mov_b32 s41, 0
att_mx:
    buffer_load_dwordx4 v[172:175], v3, s[16:19], s33 offen
    buffer_load_dword v176, v4, s[16:19], s33 offen offset:3072
    s_waitcnt vmcnt(0)
    v_mfma_f32_32x32x16_bf16 v[12:27], v[172:175], v[156:159], 0
    v_mfma_f32_32x32x16_bf16 v[12:27], v[176:179], v[160:163], v[12:27]
    v_mfma_f32_32x32x16_bf16 v[28:43], v[172:175], v[164:167], 0
    v_mfma_f32_32x32x16_bf16 v[28:43], v[176:179], v[168:171], v[28:43]
    s_nop 15
    s_nop 7
    v_max_f32 v124, v124, v12
    v_max_f32 v124, v124, v13
    v_max_f32 v124, v124, v14
    v_max_f32 v124, v124, v15
    v_max_f32 v124, v124, v16
    v_max_f32 v124, v124, v17
    v_max_f32 v124, v124, v18
    v_max_f32 v124, v124, v19
    v_max_f32 v124, v124, v20
    v_max_f32 v124, v124, v21
    v_max_f32 v124, v124, v22
    v_max_f32 v124, v124, v23
    v_max_f32 v124, v124, v24
    v_max_f32 v124, v124, v25
    v_max_f32 v124, v124, v26
    v_max_f32 v124, v124, v27
    v_max_f32 v140, v140, v28
    v_max_f32 v140, v140, v29
    v_max_f32 v140, v140, v30
    v_max_f32 v140, v140, v31
    v_max_f32 v140, v140, v32
    v_max_f32 v140, v140, v33
    v_max_f32 v140, v140, v34
    v_max_f32 v140, v140, v35
    v_max_f32 v140, v140, v36
    v_max_f32 v140, v140, v37
    v_max_f32 v140, v140, v38
    v_max_f32 v140, v140, v39
    v_max_f32 v140, v140, v40
    v_max_f32 v140, v140, v41
    v_max_f32 v140, v140, v42
    v_max_f32 v140, v140, v43
    s_add_u32 s33, s33, 3328
    s_add_u32 s41, s41, 1
    s_cmp_lt_u32 s41, 64
    s_cbranch_scc1 att_mx
    v_mov_b32 v204, v124
    v_mov_b32 v205, v124
    s_nop 1
    v_permlane32_swap_b32 v204, v205
    s_nop 1
    v_max_f32 v204, v204, v205
    v_sub_f32 v204, 0, v204
    v_mov_b32 v124, v204
    v_mov_b32 v125, v204
    v_mov_b32 v126, v204
    v_mov_b32 v127, v204
    v_mov_b32 v128, v204
    v_mov_b32 v129, v204
    v_mov_b32 v130, v204
    v_mov_b32 v131, v204
    v_mov_b32 v132, v204
    v_mov_b32 v133, v204
    v_mov_b32 v134, v204
    v_mov_b32 v135, v204
    v_mov_b32 v136, v204
    v_mov_b32 v137, v204
    v_mov_b32 v138, v204
    v_mov_b32 v139, v204
    v_mov_b32 v204, v140
    v_mov_b32 v205, v140
    s_nop 1
    v_permlane32_swap_b32 v204, v205
    s_nop 1
    v_max_f32 v204, v204, v205
    v_sub_f32 v204, 0, v204
    v_mov_b32 v140, v204
    v_mov_b32 v141, v204
    v_mov_b32 v142, v204
    v_mov_b32 v143, v204
    v_mov_b32 v144, v204
    v_mov_b32 v145, v204
    v_mov_b32 v146, v204
    v_mov_b32 v147, v204
    v_mov_b32 v148, v204
    v_mov_b32 v149, v204
    v_mov_b32 v150, v204
    v_mov_b32 v151, v204
    v_mov_b32 v152, v204
    v_mov_b32 v153, v204
    v_mov_b32 v154, v204
    v_mov_b32 v155, v204
    s_barrier
    s_branch att_pass
att_fin:
    v_mov_b32 v204, v86
    v_mov_b32 v205, v86
    s_nop 1
    v_permlane32_swap_b32 v204, v205
    s_nop 1
    v_rcp_f32 v204, v204
    s_nop 0
    v_mul_f32 v76, v204, v76
    v_mul_f32 v77, v204, v77
    v_mul_f32 v78, v204, v78
    v_mul_f32 v79, v204, v79
    v_mul_f32 v80, v204, v80
    v_mul_f32 v81, v204, v81
    v_mul_f32 v82, v204, v82
    v_mul_f32 v83, v204, v83
    v_mul_f32 v84, v204, v84
    v_mul_f32 v85, v204, v85
    v_cvt_pk_bf16_f32 v208, v76, v77
    v_cvt_pk_bf16_f32 v209, v78, v79
    v_cvt_pk_bf16_f32 v210, v80, v81
    v_cvt_pk_bf16_f32 v211, v82, v83
    v_cvt_pk_bf16_f32 v212, v84, v85
    s_nop 1
    v_permlane32_swap_b32 v208, v210
    v_permlane32_swap_b32 v209, v211
    s_add_u32 s4, s27, 0
    s_mul_i32 s4, s4, 36864
    s_add_u32 s4, s4, 28123136
    s_lshl_b32 s5, s25, 10
    s_add_u32 s5, s5, s4
    s_nop 0
    buffer_store_dwordx4 v[208:211], v3, s[16:19], s5 offen sc0 sc1
    s_lshr_b32 s5, s25, 3
    s_add_u32 s5, s5, 32
    s_lshl_b32 s5, s5, 10
    s_add_u32 s4, s4, s5
    s_bfe_u32 s5, s25, 0x10002
    s_lshl_b32 s5, s5, 9
    s_add_u32 s4, s4, s5
    s_and_b32 s5, s25, 3
    s_lshl_b32 s5, s5, 2
    s_add_u32 s4, s4, s5
    v_lshlrev_b32 v206, 4, v1
    s_mov_b32 exec_hi, 0
    buffer_store_dword v212, v206, s[16:19], s4 offen
    s_mov_b32 exec_hi, -1
    s_nop 1
    v_mov_b32 v204, v102
    v_mov_b32 v205, v102
    s_nop 1
    v_permlane32_swap_b32 v204, v205
    s_nop 1
    v_rcp_f32 v204, v204
    s_nop 0
    v_mul_f32 v92, v204, v92
    v_mul_f32 v93, v204, v93
    v_mul_f32 v94, v204, v94
    v_mul_f32 v95, v204, v95
    v_mul_f32 v96, v204, v96
    v_mul_f32 v97, v204, v97
    v_mul_f32 v98, v204, v98
    v_mul_f32 v99, v204, v99
    v_mul_f32 v100, v204, v100
    v_mul_f32 v101, v204, v101
    v_cvt_pk_bf16_f32 v208, v92, v93
    v_cvt_pk_bf16_f32 v209, v94, v95
    v_cvt_pk_bf16_f32 v210, v96, v97
    v_cvt_pk_bf16_f32 v211, v98, v99
    v_cvt_pk_bf16_f32 v212, v100, v101
    s_nop 1
    v_permlane32_swap_b32 v208, v210
    v_permlane32_swap_b32 v209, v211
    s_add_u32 s4, s27, 1
    s_mul_i32 s4, s4, 36864
    s_add_u32 s4, s4, 28123136
    s_lshl_b32 s5, s25, 10
    s_add_u32 s5, s5, s4
    s_nop 0
    buffer_store_dwordx4 v[208:211], v3, s[16:19], s5 offen sc0 sc1
    s_lshr_b32 s5, s25, 3
    s_add_u32 s5, s5, 32
    s_lshl_b32 s5, s5, 10
    s_add_u32 s4, s4, s5
    s_bfe_u32 s5, s25, 0x10002
    s_lshl_b32 s5, s5, 9
    s_add_u32 s4, s4, s5
    s_and_b32 s5, s25, 3
    s_lshl_b32 s5, s5, 2
    s_add_u32 s4, s4, s5
    v_lshlrev_b32 v206, 4, v1
    s_mov_b32 exec_hi, 0
    buffer_store_dword v212, v206, s[16:19], s4 offen
    s_mov_b32 exec_hi, -1
    s_nop 1
    s_endpgm
k2_g2:
    s_sub_u32 s4, s2, 256
    s_and_b32 s5, s4, 7
    s_lshr_b32 s6, s4, 3
    s_and_b32 s7, s6, 1
    s_lshl_b32 s5, s5, 1
    s_add_u32 s25, s5, s7
    s_lshr_b32 s6, s6, 1
    s_mul_i32 s7, s6, 43
    s_lshr_b32 s26, s7, 7
    s_mul_i32 s7, s26, 3
    s_sub_u32 s27, s6, s7
    s_mul_i32 s28, s26, 29
    s_cmp_eq_u32 s26, 4
    s_cselect_b32 s29, 28, 29
    s_load_dwordx2 s[12:13], s[0:1], 48
    s_mov_b32 s14, 5308416
    s_mov_b32 s15, 0x00020000
    s_lshl_b32 s4, s25, 2
    s_add_u32 s4, s4, s24
    s_mul_i32 s4, s4, 294912
    s_lshl_b32 s5, s28, 11
    s_add_u32 s33, s4, s5
    s_add_u32 s33, s33, 0
    s_mul_i32 s34, s28, 36864
    s_mul_i32 s4, s27, 384
    s_add_u32 s34, s34, s4
    s_add_u32 s4, s24, 0
    s_lshl_b32 s4, s4, 6
    v_add_u32 v64, s4, v1
    s_mov_b32 s5, 2731
    v_mul_lo_u32 v65, v64, s5
    v_lshrrev_b32 v65, 16, v65
    v_mul_u32_u24 v66, 24, v65
    v_sub_u32 v66, v64, v66
    v_lshlrev_b32 v67, 1, v65
    v_and_b32 v67, 4, v67
    v_xor_b32 v66, v66, v67
    v_lshlrev_b32 v66, 4, v66
    v_mul_u32_u24 v65, 1152, v65
    v_add_u32 v4, v65, v66
    s_add_u32 s4, s24, 4
    s_lshl_b32 s4, s4, 6
    v_add_u32 v64, s4, v1
    s_mov_b32 s5, 2731
    v_mul_lo_u32 v65, v64, s5
    v_lshrrev_b32 v65, 16, v65
    v_mul_u32_u24 v66, 24, v65
    v_sub_u32 v66, v64, v66
    v_lshlrev_b32 v67, 1, v65
    v_and_b32 v67, 4, v67
    v_xor_b32 v66, v66, v67
    v_lshlrev_b32 v66, 4, v66
    v_mul_u32_u24 v65, 1152, v65
    v_add_u32 v5, v65, v66
    s_add_u32 s4, s24, 8
    s_lshl_b32 s4, s4, 6
    v_add_u32 v64, s4, v1
    s_mov_b32 s5, 2731
    v_mul_lo_u32 v65, v64, s5
    v_lshrrev_b32 v65, 16, v65
    v_mul_u32_u24 v66, 24, v65
    v_sub_u32 v66, v64, v66
    v_lshlrev_b32 v67, 1, v65
    v_and_b32 v67, 4, v67
    v_xor_b32 v66, v66, v67
    v_lshlrev_b32 v66, 4, v66
    v_mul_u32_u24 v65, 1152, v65
    v_add_u32 v48, v65, v66
    s_lshl_b32 s35, s24, 11
    s_lshl_b32 s36, s24, 10
    s_add_u32 s36, s36, 8192
    s_mov_b32 s30, 0
    s_mov_b32 s38, 0
    s_waitcnt lgkmcnt(0)
    s_and_b32 s13, s13, 0xffff
    s_add_u32 m0, s30, s35
    s_nop 0
    buffer_load_dwordx4 v3, s[16:19], s33 offen lds
    buffer_load_dwordx4 v3, s[16:19], s33 offen offset:1024 lds
    s_add_u32 m0, s30, s36
    s_nop 0
    buffer_load_dwordx4 v4, s[12:15], s34 offen lds
    s_add_u32 m0, m0, 4096
    s_nop 0
    buffer_load_dwordx4 v5, s[12:15], s34 offen lds
    s_add_u32 m0, m0, 4096
    s_nop 0
    buffer_load_dwordx4 v48, s[12:15], s34 offen lds
    s_add_u32 s33, s33, 2048
    s_add_u32 s34, s34, 36864
    s_add_u32 s38, s38, 1
    s_cmp_ge_u32 s38, s29
    s_cselect_b32 s33, 0x40000000, s33
    s_cselect_b32 s34, 0x40000000, s34
    s_add_u32 s30, s30, 20480
    s_cmp_eq_u32 s30, 61440
    s_cselect_b32 s30, 0, s30
    s_add_u32 m0, s30, s35
    s_nop 0
    buffer_load_dwordx4 v3, s[16:19], s33 offen lds
    buffer_load_dwordx4 v3, s[16:19], s33 offen offset:1024 lds
    s_add_u32 m0, s30, s36
    s_nop 0
    buffer_load_dwordx4 v4, s[12:15], s34 offen lds
    s_add_u32 m0, m0, 4096
    s_nop 0
    buffer_load_dwordx4 v5, s[12:15], s34 offen lds
    s_add_u32 m0, m0, 4096
    s_nop 0
    buffer_load_dwordx4 v48, s[12:15], s34 offen lds
    s_add_u32 s33, s33, 2048
    s_add_u32 s34, s34, 36864
    s_add_u32 s38, s38, 1
    s_cmp_ge_u32 s38, s29
    s_cselect_b32 s33, 0x40000000, s33
    s_cselect_b32 s34, 0x40000000, s34
    s_add_u32 s30, s30, 20480
    s_cmp_eq_u32 s30, 61440
    s_cselect_b32 s30, 0, s30
    s_and_b32 s39, s24, 1
    s_lshr_b32 s41, s24, 1
    v_and_b32 v64, 15, v1
    v_lshrrev_b32 v65, 5, v1
    v_lshrrev_b32 v66, 2, v64
    v_lshl_add_u32 v66, v65, 3, v66
    v_bfe_u32 v67, v1, 4, 1
    v_lshlrev_b32 v67, 5, v67
    v_and_b32 v68, 3, v64
    v_lshl_add_u32 v67, v68, 3, v67
    v_mul_u32_u24 v66, 384, v66
    v_add_u32 v66, v66, v67
    v_bfe_u32 v67, v1, 3, 1
    v_xor_b32 v67, s39, v67
    v_lshl_add_u32 v66, v67, 6, v66
    v_add_u32 v50, 8192, v66
    s_lshl_b32 s4, s41, 12
    v_add_u32 v51, s4, v3
    v_mov_b32 v128, 0
    v_mov_b32 v129, 0
    v_mov_b32 v130, 0
    v_mov_b32 v131, 0
    v_mov_b32 v132, 0
    v_mov_b32 v133, 0
    v_mov_b32 v134, 0
    v_mov_b32 v135, 0
    v_mov_b32 v136, 0
    v_mov_b32 v137, 0
    v_mov_b32 v138, 0
    v_mov_b32 v139, 0
    v_mov_b32 v140, 0
    v_mov_b32 v141, 0
    v_mov_b32 v142, 0
    v_mov_b32 v143, 0
    v_mov_b32 v144, 0
    v_mov_b32 v145, 0
    v_mov_b32 v146, 0
    v_mov_b32 v147, 0
    v_mov_b32 v148, 0
    v_mov_b32 v149, 0
    v_mov_b32 v150, 0
    v_mov_b32 v151, 0
    v_mov_b32 v152, 0
    v_mov_b32 v153, 0
    v_mov_b32 v154, 0
    v_mov_b32 v155, 0
    v_mov_b32 v156, 0
    v_mov_b32 v157, 0
    v_mov_b32 v158, 0
    v_mov_b32 v159, 0
    v_mov_b32 v160, 0
    v_mov_b32 v161, 0
    v_mov_b32 v162, 0
    v_mov_b32 v163, 0
    v_mov_b32 v164, 0
    v_mov_b32 v165, 0
    v_mov_b32 v166, 0
    v_mov_b32 v167, 0
    v_mov_b32 v168, 0
    v_mov_b32 v169, 0
    v_mov_b32 v170, 0
    v_mov_b32 v171, 0
    v_mov_b32 v172, 0
    v_mov_b32 v173, 0
    v_mov_b32 v174, 0
    v_mov_b32 v175, 0
    v_mov_b32 v176, 0
    v_mov_b32 v177, 0
    v_mov_b32 v178, 0
    v_mov_b32 v179, 0
    v_mov_b32 v180, 0
    v_mov_b32 v181, 0
    v_mov_b32 v182, 0
    v_mov_b32 v183, 0
    v_mov_b32 v184, 0
    v_mov_b32 v185, 0
    v_mov_b32 v186, 0
    v_mov_b32 v187, 0
    v_mov_b32 v188, 0
    v_mov_b32 v189, 0
    v_mov_b32 v190, 0
    v_mov_b32 v191, 0
    v_mov_b32 v192, 0
    v_mov_b32 v193, 0
    v_mov_b32 v194, 0
    v_mov_b32 v195, 0
    v_mov_b32 v196, 0
    v_mov_b32 v197, 0
    v_mov_b32 v198, 0
    v_mov_b32 v199, 0
    v_mov_b32 v200, 0
    v_mov_b32 v201, 0
    v_mov_b32 v202, 0
    v_mov_b32 v203, 0
    v_mov_b32 v204, 0
    v_mov_b32 v205, 0
    v_mov_b32 v206, 0
    v_mov_b32 v207, 0
    v_mov_b32 v208, 0
    v_mov_b32 v209, 0
    v_mov_b32 v210, 0
    v_mov_b32 v211, 0
    v_mov_b32 v212, 0
    v_mov_b32 v213, 0
    v_mov_b32 v214, 0
    v_mov_b32 v215, 0
    v_mov_b32 v216, 0
    v_mov_b32 v217, 0
    v_mov_b32 v218, 0
    v_mov_b32 v219, 0
    v_mov_b32 v220, 0
    v_mov_b32 v221, 0
    v_mov_b32 v222, 0
    v_mov_b32 v223, 0
    s_mov_b32 s40, 0
    s_mov_b32 s42, 0
g2_loop:
    s_waitcnt vmcnt(5)
    s_barrier
    v_add_u32 v52, s40, v50
    v_add_u32 v53, s40, v51
    ds_read_b128 v[8:11], v53 offset:0
    ds_read_b128 v[12:15], v53 offset:2048
    ds_read_b64_tr_b16 v[24:25], v52 offset:0
    ds_read_b64_tr_b16 v[26:27], v52 offset:1536
    ds_read_b64_tr_b16 v[28:29], v52 offset:128
    ds_read_b64_tr_b16 v[30:31], v52 offset:1664
    ds_read_b64_tr_b16 v[32:33], v52 offset:256
    ds_read_b64_tr_b16 v[34:35], v52 offset:1792
    s_add_u32 m0, s30, s35
    s_nop 0
    buffer_load_dwordx4 v3, s[16:19], s33 offen lds
    buffer_load_dwordx4 v3, s[16:19], s33 offen offset:1024 lds
    ds_read_b128 v[16:19], v53 offset:1024
    ds_read_b128 v[20:23], v53 offset:3072
    ds_read_b64_tr_b16 v[36:37], v52 offset:6144
    ds_read_b64_tr_b16 v[38:39], v52 offset:7680
    ds_read_b64_tr_b16 v[40:41], v52 offset:6272
    ds_read_b64_tr_b16 v[42:43], v52 offset:7808
    ds_read_b64_tr_b16 v[44:45], v52 offset:6400
    ds_read_b64_tr_b16 v[46:47], v52 offset:7936
    s_waitcnt lgkmcnt(8)
    v_mfma_f32_32x32x16_bf16 v[128:143], v[24:27], v[8:11], v[128:143]
    v_mfma_f32_32x32x16_bf16 v[144:159], v[24:27], v[12:15], v[144:159]
    s_add_u32 m0, s30, s36
    s_nop 0
    buffer_load_dwordx4 v4, s[12:15], s34 offen lds
    v_mfma_f32_32x32x16_bf16 v[160:175], v[28:31], v[8:11], v[160:175]
    v_mfma_f32_32x32x16_bf16 v[176:191], v[28:31], v[12:15], v[176:191]
    s_add_u32 m0, m0, 4096
    s_nop 0
    buffer_load_dwordx4 v5, s[12:15], s34 offen lds
    v_mfma_f32_32x32x16_bf16 v[192:207], v[32:35], v[8:11], v[192:207]
    v_mfma_f32_32x32x16_bf16 v[208:223], v[32:35], v[12:15], v[208:223]
    s_add_u32 m0, m0, 4096
    s_nop 0
    buffer_load_dwordx4 v48, s[12:15], s34 offen lds
    s_add_u32 s33, s33, 2048
    s_add_u32 s34, s34, 36864
    s_add_u32 s38, s38, 1
    s_cmp_ge_u32 s38, s29
    s_cselect_b32 s33, 0x40000000, s33
    s_cselect_b32 s34, 0x40000000, s34
    s_add_u32 s30, s30, 20480
    s_cmp_eq_u32 s30, 61440
    s_cselect_b32 s30, 0, s30
    s_waitcnt lgkmcnt(0)
    v_mfma_f32_32x32x16_bf16 v[128:143], v[36:39], v[16:19], v[128:143]
    v_mfma_f32_32x32x16_bf16 v[144:159], v[36:39], v[20:23], v[144:159]
    v_mfma_f32_32x32x16_bf16 v[160:175], v[40:43], v[16:19], v[160:175]
    v_mfma_f32_32x32x16_bf16 v[176:191], v[40:43], v[20:23], v[176:191]
    v_mfma_f32_32x32x16_bf16 v[192:207], v[44:47], v[16:19], v[192:207]
    v_mfma_f32_32x32x16_bf16 v[208:223], v[44:47], v[20:23], v[208:223]
    s_add_u32 s40, s40, 20480
    s_cmp_eq_u32 s40, 61440
    s_cselect_b32 s40, 0, s40
    s_add_u32 s42, s42, 1
    s_cmp_lt_u32 s42, s29
    s_cbranch_scc1 g2_loop
    s_waitcnt vmcnt(0)
    s_nop 15
    s_nop 7
    v_cvt_pk_bf16_f32 v64, v128, v129
    v_cvt_pk_bf16_f32 v65, v130, v131
    v_cvt_pk_bf16_f32 v66, v132, v133
    v_cvt_pk_bf16_f32 v67, v134, v135
    v_cvt_pk_bf16_f32 v68, v136, v137
    v_cvt_pk_bf16_f32 v69, v138, v139
    v_cvt_pk_bf16_f32 v70, v140, v141
    v_cvt_pk_bf16_f32 v71, v142, v143
    s_lshl_b32 s4, s26, 6
    s_lshl_b32 s5, s25, 2
    s_add_u32 s4, s4, s5
    s_lshl_b32 s5, s41, 1
    s_add_u32 s4, s4, s5
    s_add_u32 s4, s4, 0
    s_mul_i32 s4, s4, 18
    s_mul_i32 s5, s27, 6
    s_add_u32 s4, s4, s5
    s_add_u32 s4, s4, s39
    s_add_u32 s4, s4, 0
    s_lshl_b32 s4, s4, 11
    s_add_u32 s4, s4, 31145984
    buffer_store_dwordx4 v[64:67], v3, s[16:19], s4 offen sc0 sc1
    buffer_store_dwordx4 v[68:71], v3, s[16:19], s4 offen offset:1024 sc0 sc1
    s_nop 1
    v_cvt_pk_bf16_f32 v72, v144, v145
    v_cvt_pk_bf16_f32 v73, v146, v147
    v_cvt_pk_bf16_f32 v74, v148, v149
    v_cvt_pk_bf16_f32 v75, v150, v151
    v_cvt_pk_bf16_f32 v76, v152, v153
    v_cvt_pk_bf16_f32 v77, v154, v155
    v_cvt_pk_bf16_f32 v78, v156, v157
    v_cvt_pk_bf16_f32 v79, v158, v159
    s_lshl_b32 s4, s26, 6
    s_lshl_b32 s5, s25, 2
    s_add_u32 s4, s4, s5
    s_lshl_b32 s5, s41, 1
    s_add_u32 s4, s4, s5
    s_add_u32 s4, s4, 1
    s_mul_i32 s4, s4, 18
    s_mul_i32 s5, s27, 6
    s_add_u32 s4, s4, s5
    s_add_u32 s4, s4, s39
    s_add_u32 s4, s4, 0
    s_lshl_b32 s4, s4, 11
    s_add_u32 s4, s4, 31145984
    buffer_store_dwordx4 v[72:75], v3, s[16:19], s4 offen sc0 sc1
    buffer_store_dwordx4 v[76:79], v3, s[16:19], s4 offen offset:1024 sc0 sc1
    s_nop 1
    v_cvt_pk_bf16_f32 v80, v160, v161
    v_cvt_pk_bf16_f32 v81, v162, v163
    v_cvt_pk_bf16_f32 v82, v164, v165
    v_cvt_pk_bf16_f32 v83, v166, v167
    v_cvt_pk_bf16_f32 v84, v168, v169
    v_cvt_pk_bf16_f32 v85, v170, v171
    v_cvt_pk_bf16_f32 v86, v172, v173
    v_cvt_pk_bf16_f32 v87, v174, v175
    s_lshl_b32 s4, s26, 6
    s_lshl_b32 s5, s25, 2
    s_add_u32 s4, s4, s5
    s_lshl_b32 s5, s41, 1
    s_add_u32 s4, s4, s5
    s_add_u32 s4, s4, 0
    s_mul_i32 s4, s4, 18
    s_mul_i32 s5, s27, 6
    s_add_u32 s4, s4, s5
    s_add_u32 s4, s4, s39
    s_add_u32 s4, s4, 2
    s_lshl_b32 s4, s4, 11
    s_add_u32 s4, s4, 31145984
    buffer_store_dwordx4 v[80:83], v3, s[16:19], s4 offen sc0 sc1
    buffer_store_dwordx4 v[84:87], v3, s[16:19], s4 offen offset:1024 sc0 sc1
    s_nop 1
    v_cvt_pk_bf16_f32 v88, v176, v177
    v_cvt_pk_bf16_f32 v89, v178, v179
    v_cvt_pk_bf16_f32 v90, v180, v181
    v_cvt_pk_bf16_f32 v91, v182, v183
    v_cvt_pk_bf16_f32 v92, v184, v185
    v_cvt_pk_bf16_f32 v93, v186, v187
    v_cvt_pk_bf16_f32 v94, v188, v189
    v_cvt_pk_bf16_f32 v95, v190, v191
    s_lshl_b32 s4, s26, 6
    s_lshl_b32 s5, s25, 2
    s_add_u32 s4, s4, s5
    s_lshl_b32 s5, s41, 1
    s_add_u32 s4, s4, s5
    s_add_u32 s4, s4, 1
    s_mul_i32 s4, s4, 18
    s_mul_i32 s5, s27, 6
    s_add_u32 s4, s4, s5
    s_add_u32 s4, s4, s39
    s_add_u32 s4, s4, 2
    s_lshl_b32 s4, s4, 11
    s_add_u32 s4, s4, 31145984
    buffer_store_dwordx4 v[88:91], v3, s[16:19], s4 offen sc0 sc1
    buffer_store_dwordx4 v[92:95], v3, s[16:19], s4 offen offset:1024 sc0 sc1
    s_nop 1
    v_cvt_pk_bf16_f32 v64, v192, v193
    v_cvt_pk_bf16_f32 v65, v194, v195
    v_cvt_pk_bf16_f32 v66, v196, v197
    v_cvt_pk_bf16_f32 v67, v198, v199
    v_cvt_pk_bf16_f32 v68, v200, v201
    v_cvt_pk_bf16_f32 v69, v202, v203
    v_cvt_pk_bf16_f32 v70, v204, v205
    v_cvt_pk_bf16_f32 v71, v206, v207
    s_lshl_b32 s4, s26, 6
    s_lshl_b32 s5, s25, 2
    s_add_u32 s4, s4, s5
    s_lshl_b32 s5, s41, 1
    s_add_u32 s4, s4, s5
    s_add_u32 s4, s4, 0
    s_mul_i32 s4, s4, 18
    s_mul_i32 s5, s27, 6
    s_add_u32 s4, s4, s5
    s_add_u32 s4, s4, s39
    s_add_u32 s4, s4, 4
    s_lshl_b32 s4, s4, 11
    s_add_u32 s4, s4, 31145984
    buffer_store_dwordx4 v[64:67], v3, s[16:19], s4 offen sc0 sc1
    buffer_store_dwordx4 v[68:71], v3, s[16:19], s4 offen offset:1024 sc0 sc1
    s_nop 1
    v_cvt_pk_bf16_f32 v72, v208, v209
    v_cvt_pk_bf16_f32 v73, v210, v211
    v_cvt_pk_bf16_f32 v74, v212, v213
    v_cvt_pk_bf16_f32 v75, v214, v215
    v_cvt_pk_bf16_f32 v76, v216, v217
    v_cvt_pk_bf16_f32 v77, v218, v219
    v_cvt_pk_bf16_f32 v78, v220, v221
    v_cvt_pk_bf16_f32 v79, v222, v223
    s_lshl_b32 s4, s26, 6
    s_lshl_b32 s5, s25, 2
    s_add_u32 s4, s4, s5
    s_lshl_b32 s5, s41, 1
    s_add_u32 s4, s4, s5
    s_add_u32 s4, s4, 1
    s_mul_i32 s4, s4, 18
    s_mul_i32 s5, s27, 6
    s_add_u32 s4, s4, s5
    s_add_u32 s4, s4, s39
    s_add_u32 s4, s4, 4
    s_lshl_b32 s4, s4, 11
    s_add_u32 s4, s4, 31145984
    buffer_store_dwordx4 v[72:75], v3, s[16:19], s4 offen sc0 sc1
    buffer_store_dwordx4 v[76:79], v3, s[16:19], s4 offen offset:1024 sc0 sc1
    s_nop 1
    s_endpgm
k2_prep:
    s_sub_u32 s4, s2, 496
    s_lshl_b32 s4, s4, 2
    s_add_u32 s27, s4, s24
    s_load_dwordx2 s[12:13], s[0:1], 16
    s_mov_b32 s14, 663552
    s_mov_b32 s15, 0x00020000
    v_and_b32 v64, 31, v1
    v_lshlrev_b32 v64, 1, v64
    v_lshrrev_b32 v65, 5, v1
    s_cmp_ge_u32 s27, 32
    s_mov_b32 s5, 9216
    s_cselect_b32 s5, 82944, s5
    v_mul_lo_u32 v66, s5, v65
    v_add_u32 v66, v66, v64
    s_mul_i32 s28, s27, 20736
    s_sub_u32 s29, s27, 32
    s_mul_i32 s29, s29, 165888
    s_add_u32 s29, s29, 18432
    s_add_u32 s4, s28, 0
    s_add_u32 s5, s29, 0
    s_cmp_ge_u32 s27, 32
    s_cselect_b32 s48, s5, s4
    s_add_u32 s4, s28, 1152
    s_add_u32 s5, s29, 1152
    s_cmp_ge_u32 s27, 32
    s_cselect_b32 s49, s5, s4
    s_add_u32 s4, s28, 2304
    s_add_u32 s5, s29, 20736
    s_cmp_ge_u32 s27, 32
    s_cselect_b32 s50, s5, s4
    s_add_u32 s4, s28, 3456
    s_add_u32 s5, s29, 21888
    s_cmp_ge_u32 s27, 32
    s_cselect_b32 s51, s5, s4
    s_add_u32 s4, s28, 4608
    s_add_u32 s5, s29, 41472
    s_cmp_ge_u32 s27, 32
    s_cselect_b32 s52, s5, s4
    s_add_u32 s4, s28, 5760
    s_add_u32 s5, s29, 42624
    s_cmp_ge_u32 s27, 32
    s_cselect_b32 s53, s5, s4
    s_add_u32 s4, s28, 6912
    s_add_u32 s5, s29, 62208
    s_cmp_ge_u32 s27, 32
    s_cselect_b32 s54, s5, s4
    s_add_u32 s4, s28, 8064
    s_add_u32 s5, s29, 63360
    s_cmp_ge_u32 s27, 32
    s_cselect_b32 s55, s5, s4
    s_waitcnt lgkmcnt(0)
    s_and_b32 s13, s13, 0xffff
    s_lshl_b32 s4, s27, 10
    s_add_u32 s4, s4, 30482432
    buffer_load_ushort v120, v66, s[12:15], s48 offen offset:0
    buffer_load_ushort v121, v66, s[12:15], s49 offen offset:0
    buffer_load_ushort v122, v66, s[12:15], s50 offen offset:0
    buffer_load_ushort v123, v66, s[12:15], s51 offen offset:0
    buffer_load_ushort v124, v66, s[12:15], s52 offen offset:0
    buffer_load_ushort v125, v66, s[12:15], s53 offen offset:0
    buffer_load_ushort v126, v66, s[12:15], s54 offen offset:0
    buffer_load_ushort v127, v66, s[12:15], s55 offen offset:0
    buffer_load_ushort v128, v66, s[12:15], s48 offen offset:64
    buffer_load_ushort v129, v66, s[12:15], s49 offen offset:64
    buffer_load_ushort v130, v66, s[12:15], s50 offen offset:64
    buffer_load_ushort v131, v66, s[12:15], s51 offen offset:64
    buffer_load_ushort v132, v66, s[12:15], s52 offen offset:64
    buffer_load_ushort v133, v66, s[12:15], s53 offen offset:64
    buffer_load_ushort v134, v66, s[12:15], s54 offen offset:64
    buffer_load_ushort v135, v66, s[12:15], s55 offen offset:64
    buffer_load_ushort v136, v66, s[12:15], s48 offen offset:128
    buffer_load_ushort v137, v66, s[12:15], s49 offen offset:128
    buffer_load_ushort v138, v66, s[12:15], s50 offen offset:128
    buffer_load_ushort v139, v66, s[12:15], s51 offen offset:128
    buffer_load_ushort v140, v66, s[12:15], s52 offen offset:128
    buffer_load_ushort v141, v66, s[12:15], s53 offen offset:128
    buffer_load_ushort v142, v66, s[12:15], s54 offen offset:128
    buffer_load_ushort v143, v66, s[12:15], s55 offen offset:128
    buffer_load_ushort v144, v66, s[12:15], s48 offen offset:192
    buffer_load_ushort v145, v66, s[12:15], s49 offen offset:192
    buffer_load_ushort v146, v66, s[12:15], s50 offen offset:192
    buffer_load_ushort v147, v66, s[12:15], s51 offen offset:192
    buffer_load_ushort v148, v66, s[12:15], s52 offen offset:192
    buffer_load_ushort v149, v66, s[12:15], s53 offen offset:192
    buffer_load_ushort v150, v66, s[12:15], s54 offen offset:192
    buffer_load_ushort v151, v66, s[12:15], s55 offen offset:192
    buffer_load_ushort v152, v66, s[12:15], s48 offen offset:256
    buffer_load_ushort v153, v66, s[12:15], s49 offen offset:256
    buffer_load_ushort v154, v66, s[12:15], s50 offen offset:256
    buffer_load_ushort v155, v66, s[12:15], s51 offen offset:256
    buffer_load_ushort v156, v66, s[12:15], s52 offen offset:256
    buffer_load_ushort v157, v66, s[12:15], s53 offen offset:256
    buffer_load_ushort v158, v66, s[12:15], s54 offen offset:256
    buffer_load_ushort v159, v66, s[12:15], s55 offen offset:256
    buffer_load_ushort v160, v66, s[12:15], s48 offen offset:320
    buffer_load_ushort v161, v66, s[12:15], s49 offen offset:320
    buffer_load_ushort v162, v66, s[12:15], s50 offen offset:320
    buffer_load_ushort v163, v66, s[12:15], s51 offen offset:320
    buffer_load_ushort v164, v66, s[12:15], s52 offen offset:320
    buffer_load_ushort v165, v66, s[12:15], s53 offen offset:320
    buffer_load_ushort v166, v66, s[12:15], s54 offen offset:320
    buffer_load_ushort v167, v66, s[12:15], s55 offen offset:320
    s_waitcnt vmcnt(0)
    v_lshl_or_b32 v80, v121, 16, v120
    v_lshl_or_b32 v81, v123, 16, v122
    v_lshl_or_b32 v82, v125, 16, v124
    v_lshl_or_b32 v83, v127, 16, v126
    v_lshl_or_b32 v84, v129, 16, v128
    v_lshl_or_b32 v85, v131, 16, v130
    v_lshl_or_b32 v86, v133, 16, v132
    v_lshl_or_b32 v87, v135, 16, v134
    v_lshl_or_b32 v88, v137, 16, v136
    v_lshl_or_b32 v89, v139, 16, v138
    v_lshl_or_b32 v90, v141, 16, v140
    v_lshl_or_b32 v91, v143, 16, v142
    v_lshl_or_b32 v92, v145, 16, v144
    v_lshl_or_b32 v93, v147, 16, v146
    v_lshl_or_b32 v94, v149, 16, v148
    v_lshl_or_b32 v95, v151, 16, v150
    v_lshl_or_b32 v96, v153, 16, v152
    v_lshl_or_b32 v97, v155, 16, v154
    v_lshl_or_b32 v98, v157, 16, v156
    v_lshl_or_b32 v99, v159, 16, v158
    v_lshl_or_b32 v100, v161, 16, v160
    v_lshl_or_b32 v101, v163, 16, v162
    v_lshl_or_b32 v102, v165, 16, v164
    v_lshl_or_b32 v103, v167, 16, v166
    buffer_store_dwordx4 v[80:83], v3, s[16:19], s4 offen
    s_add_u32 s4, s4, 36864
    buffer_store_dwordx4 v[84:87], v3, s[16:19], s4 offen
    s_add_u32 s4, s4, 36864
    buffer_store_dwordx4 v[88:91], v3, s[16:19], s4 offen
    s_add_u32 s4, s4, 36864
    buffer_store_dwordx4 v[92:95], v3, s[16:19], s4 offen
    s_add_u32 s4, s4, 36864
    buffer_store_dwordx4 v[96:99], v3, s[16:19], s4 offen
    s_add_u32 s4, s4, 36864
    buffer_store_dwordx4 v[100:103], v3, s[16:19], s4 offen
    s_add_u32 s4, s4, 36864
    s_nop 1
    buffer_load_ushort v120, v66, s[12:15], s48 offen offset:384
    buffer_load_ushort v121, v66, s[12:15], s49 offen offset:384
    buffer_load_ushort v122, v66, s[12:15], s50 offen offset:384
    buffer_load_ushort v123, v66, s[12:15], s51 offen offset:384
    buffer_load_ushort v124, v66, s[12:15], s52 offen offset:384
    buffer_load_ushort v125, v66, s[12:15], s53 offen offset:384
    buffer_load_ushort v126, v66, s[12:15], s54 offen offset:384
    buffer_load_ushort v127, v66, s[12:15], s55 offen offset:384
    buffer_load_ushort v128, v66, s[12:15], s48 offen offset:448
    buffer_load_ushort v129, v66, s[12:15], s49 offen offset:448
    buffer_load_ushort v130, v66, s[12:15], s50 offen offset:448
    buffer_load_ushort v131, v66, s[12:15], s51 offen offset:448
    buffer_load_ushort v132, v66, s[12:15], s52 offen offset:448
    buffer_load_ushort v133, v66, s[12:15], s53 offen offset:448
    buffer_load_ushort v134, v66, s[12:15], s54 offen offset:448
    buffer_load_ushort v135, v66, s[12:15], s55 offen offset:448
    buffer_load_ushort v136, v66, s[12:15], s48 offen offset:512
    buffer_load_ushort v137, v66, s[12:15], s49 offen offset:512
    buffer_load_ushort v138, v66, s[12:15], s50 offen offset:512
    buffer_load_ushort v139, v66, s[12:15], s51 offen offset:512
    buffer_load_ushort v140, v66, s[12:15], s52 offen offset:512
    buffer_load_ushort v141, v66, s[12:15], s53 offen offset:512
    buffer_load_ushort v142, v66, s[12:15], s54 offen offset:512
    buffer_load_ushort v143, v66, s[12:15], s55 offen offset:512
    buffer_load_ushort v144, v66, s[12:15], s48 offen offset:576
    buffer_load_ushort v145, v66, s[12:15], s49 offen offset:576
    buffer_load_ushort v146, v66, s[12:15], s50 offen offset:576
    buffer_load_ushort v147, v66, s[12:15], s51 offen offset:576
    buffer_load_ushort v148, v66, s[12:15], s52 offen offset:576
    buffer_load_ushort v149, v66, s[12:15], s53 offen offset:576
    buffer_load_ushort v150, v66, s[12:15], s54 offen offset:576
    buffer_load_ushort v151, v66, s[12:15], s55 offen offset:576
    buffer_load_ushort v152, v66, s[12:15], s48 offen offset:640
    buffer_load_ushort v153, v66, s[12:15], s49 offen offset:640
    buffer_load_ushort v154, v66, s[12:15], s50 offen offset:640
    buffer_load_ushort v155, v66, s[12:15], s51 offen offset:640
    buffer_load_ushort v156, v66, s[12:15], s52 offen offset:640
    buffer_load_ushort v157, v66, s[12:15], s53 offen offset:640
    buffer_load_ushort v158, v66, s[12:15], s54 offen offset:640
    buffer_load_ushort v159, v66, s[12:15], s55 offen offset:640
    buffer_load_ushort v160, v66, s[12:15], s48 offen offset:704
    buffer_load_ushort v161, v66, s[12:15], s49 offen offset:704
    buffer_load_ushort v162, v66, s[12:15], s50 offen offset:704
    buffer_load_ushort v163, v66, s[12:15], s51 offen offset:704
    buffer_load_ushort v164, v66, s[12:15], s52 offen offset:704
    buffer_load_ushort v165, v66, s[12:15], s53 offen offset:704
    buffer_load_ushort v166, v66, s[12:15], s54 offen offset:704
    buffer_load_ushort v167, v66, s[12:15], s55 offen offset:704
    s_waitcnt vmcnt(0)
    v_lshl_or_b32 v80, v121, 16, v120
    v_lshl_or_b32 v81, v123, 16, v122
    v_lshl_or_b32 v82, v125, 16, v124
    v_lshl_or_b32 v83, v127, 16, v126
    v_lshl_or_b32 v84, v129, 16, v128
    v_lshl_or_b32 v85, v131, 16, v130
    v_lshl_or_b32 v86, v133, 16, v132
    v_lshl_or_b32 v87, v135, 16, v134
    v_lshl_or_b32 v88, v137, 16, v136
    v_lshl_or_b32 v89, v139, 16, v138
    v_lshl_or_b32 v90, v141, 16, v140
    v_lshl_or_b32 v91, v143, 16, v142
    v_lshl_or_b32 v92, v145, 16, v144
    v_lshl_or_b32 v93, v147, 16, v146
    v_lshl_or_b32 v94, v149, 16, v148
    v_lshl_or_b32 v95, v151, 16, v150
    v_lshl_or_b32 v96, v153, 16, v152
    v_lshl_or_b32 v97, v155, 16, v154
    v_lshl_or_b32 v98, v157, 16, v156
    v_lshl_or_b32 v99, v159, 16, v158
    v_lshl_or_b32 v100, v161, 16, v160
    v_lshl_or_b32 v101, v163, 16, v162
    v_lshl_or_b32 v102, v165, 16, v164
    v_lshl_or_b32 v103, v167, 16, v166
    buffer_store_dwordx4 v[80:83], v3, s[16:19], s4 offen
    s_add_u32 s4, s4, 36864
    buffer_store_dwordx4 v[84:87], v3, s[16:19], s4 offen
    s_add_u32 s4, s4, 36864
    buffer_store_dwordx4 v[88:91], v3, s[16:19], s4 offen
    s_add_u32 s4, s4, 36864
    buffer_store_dwordx4 v[92:95], v3, s[16:19], s4 offen
    s_add_u32 s4, s4, 36864
    buffer_store_dwordx4 v[96:99], v3, s[16:19], s4 offen
    s_add_u32 s4, s4, 36864
    buffer_store_dwordx4 v[100:103], v3, s[16:19], s4 offen
    s_add_u32 s4, s4, 36864
    s_nop 1
    buffer_load_ushort v120, v66, s[12:15], s48 offen offset:768
    buffer_load_ushort v121, v66, s[12:15], s49 offen offset:768
    buffer_load_ushort v122, v66, s[12:15], s50 offen offset:768
    buffer_load_ushort v123, v66, s[12:15], s51 offen offset:768
    buffer_load_ushort v124, v66, s[12:15], s52 offen offset:768
    buffer_load_ushort v125, v66, s[12:15], s53 offen offset:768
    buffer_load_ushort v126, v66, s[12:15], s54 offen offset:768
    buffer_load_ushort v127, v66, s[12:15], s55 offen offset:768
    buffer_load_ushort v128, v66, s[12:15], s48 offen offset:832
    buffer_load_ushort v129, v66, s[12:15], s49 offen offset:832
    buffer_load_ushort v130, v66, s[12:15], s50 offen offset:832
    buffer_load_ushort v131, v66, s[12:15], s51 offen offset:832
    buffer_load_ushort v132, v66, s[12:15], s52 offen offset:832
    buffer_load_ushort v133, v66, s[12:15], s53 offen offset:832
    buffer_load_ushort v134, v66, s[12:15], s54 offen offset:832
    buffer_load_ushort v135, v66, s[12:15], s55 offen offset:832
    buffer_load_ushort v136, v66, s[12:15], s48 offen offset:896
    buffer_load_ushort v137, v66, s[12:15], s49 offen offset:896
    buffer_load_ushort v138, v66, s[12:15], s50 offen offset:896
    buffer_load_ushort v139, v66, s[12:15], s51 offen offset:896
    buffer_load_ushort v140, v66, s[12:15], s52 offen offset:896
    buffer_load_ushort v141, v66, s[12:15], s53 offen offset:896
    buffer_load_ushort v142, v66, s[12:15], s54 offen offset:896
    buffer_load_ushort v143, v66, s[12:15], s55 offen offset:896
    buffer_load_ushort v144, v66, s[12:15], s48 offen offset:960
    buffer_load_ushort v145, v66, s[12:15], s49 offen offset:960
    buffer_load_ushort v146, v66, s[12:15], s50 offen offset:960
    buffer_load_ushort v147, v66, s[12:15], s51 offen offset:960
    buffer_load_ushort v148, v66, s[12:15], s52 offen offset:960
    buffer_load_ushort v149, v66, s[12:15], s53 offen offset:960
    buffer_load_ushort v150, v66, s[12:15], s54 offen offset:960
    buffer_load_ushort v151, v66, s[12:15], s55 offen offset:960
    buffer_load_ushort v152, v66, s[12:15], s48 offen offset:1024
    buffer_load_ushort v153, v66, s[12:15], s49 offen offset:1024
    buffer_load_ushort v154, v66, s[12:15], s50 offen offset:1024
    buffer_load_ushort v155, v66, s[12:15], s51 offen offset:1024
    buffer_load_ushort v156, v66, s[12:15], s52 offen offset:1024
    buffer_load_ushort v157, v66, s[12:15], s53 offen offset:1024
    buffer_load_ushort v158, v66, s[12:15], s54 offen offset:1024
    buffer_load_ushort v159, v66, s[12:15], s55 offen offset:1024
    buffer_load_ushort v160, v66, s[12:15], s48 offen offset:1088
    buffer_load_ushort v161, v66, s[12:15], s49 offen offset:1088
    buffer_load_ushort v162, v66, s[12:15], s50 offen offset:1088
    buffer_load_ushort v163, v66, s[12:15], s51 offen offset:1088
    buffer_load_ushort v164, v66, s[12:15], s52 offen offset:1088
    buffer_load_ushort v165, v66, s[12:15], s53 offen offset:1088
    buffer_load_ushort v166, v66, s[12:15], s54 offen offset:1088
    buffer_load_ushort v167, v66, s[12:15], s55 offen offset:1088
    s_waitcnt vmcnt(0)
    v_lshl_or_b32 v80, v121, 16, v120
    v_lshl_or_b32 v81, v123, 16, v122
    v_lshl_or_b32 v82, v125, 16, v124
    v_lshl_or_b32 v83, v127, 16, v126
    v_lshl_or_b32 v84, v129, 16, v128
    v_lshl_or_b32 v85, v131, 16, v130
    v_lshl_or_b32 v86, v133, 16, v132
    v_lshl_or_b32 v87, v135, 16, v134
    v_lshl_or_b32 v88, v137, 16, v136
    v_lshl_or_b32 v89, v139, 16, v138
    v_lshl_or_b32 v90, v141, 16, v140
    v_lshl_or_b32 v91, v143, 16, v142
    v_lshl_or_b32 v92, v145, 16, v144
    v_lshl_or_b32 v93, v147, 16, v146
    v_lshl_or_b32 v94, v149, 16, v148
    v_lshl_or_b32 v95, v151, 16, v150
    v_lshl_or_b32 v96, v153, 16, v152
    v_lshl_or_b32 v97, v155, 16, v154
    v_lshl_or_b32 v98, v157, 16, v156
    v_lshl_or_b32 v99, v159, 16, v158
    v_lshl_or_b32 v100, v161, 16, v160
    v_lshl_or_b32 v101, v163, 16, v162
    v_lshl_or_b32 v102, v165, 16, v164
    v_lshl_or_b32 v103, v167, 16, v166
    buffer_store_dwordx4 v[80:83], v3, s[16:19], s4 offen
    s_add_u32 s4, s4, 36864
    buffer_store_dwordx4 v[84:87], v3, s[16:19], s4 offen
    s_add_u32 s4, s4, 36864
    buffer_store_dwordx4 v[88:91], v3, s[16:19], s4 offen
    s_add_u32 s4, s4, 36864
    buffer_store_dwordx4 v[92:95], v3, s[16:19], s4 offen
    s_add_u32 s4, s4, 36864
    buffer_store_dwordx4 v[96:99], v3, s[16:19], s4 offen
    s_add_u32 s4, s4, 36864
    buffer_store_dwordx4 v[100:103], v3, s[16:19], s4 offen
    s_add_u32 s4, s4, 36864
    s_nop 1
    s_endpgm
k2_end:
    s_endpgm
.text
.globl k3_kernel
.p2align 8
.type k3_kernel,@function
k3_kernel:
    s_cmp_ge_u32 s2, 192
    s_cbranch_scc1 k3_end
    s_and_b32 s4, s2, 7
    s_lshr_b32 s5, s2, 3
    s_and_b32 s6, s5, 3
    s_lshl_b32 s4, s4, 2
    s_add_u32 s25, s4, s6
    s_lshr_b32 s26, s5, 2
    v_lshrrev_b32 v2, 6, v0
    v_and_b32 v1, 63, v0
    s_nop 0
    v_readfirstlane_b32 s24, v2
    v_lshlrev_b32 v3, 4, v1
    s_load_dwordx2 s[16:17], s[0:1], 88
    s_mov_b32 s18, 42942464
    s_mov_b32 s19, 0x00020000
    s_load_dwordx2 s[8:9], s[0:1], 72
    s_mov_b32 s10, 2359296
    s_mov_b32 s11, 0x00020000
    s_load_dwordx2 s[12:13], s[0:1], 56
    s_mov_b32 s14, 1152
    s_mov_b32 s15, 0x00020000
    s_waitcnt lgkmcnt(0)
    s_and_b32 s9, s9, 0xffff
    s_and_b32 s13, s13, 0xffff
    s_and_b32 s17, s17, 0xffff
    s_mul_i32 s27, s24, 6144
    s_mul_i32 s28, s25, 73728
    s_add_u32 s28, s28, s27
    s_add_u32 s28, s28, 28123136
    s_mul_i32 s29, s26, 110592
    s_add_u32 s29, s29, s27
    s_add_u32 s29, s29, 30482432
    s_add_u32 s30, s28, 36864
    s_add_u32 s31, s29, 36864
    s_add_u32 s32, s29, 73728
    buffer_load_dwordx4 v[40:43], v3, s[16:19], s28 offen offset:0
    buffer_load_dwordx4 v[44:47], v3, s[16:19], s30 offen offset:0
    buffer_load_dwordx4 v[48:51], v3, s[16:19], s29 offen offset:0
    buffer_load_dwordx4 v[52:55], v3, s[16:19], s31 offen offset:0
    buffer_load_dwordx4 v[56:59], v3, s[16:19], s32 offen offset:0
    buffer_load_dwordx4 v[60:63], v3, s[16:19], s28 offen offset:1024
    buffer_load_dwordx4 v[64:67], v3, s[16:19], s30 offen offset:1024
    buffer_load_dwordx4 v[68:71], v3, s[16:19], s29 offen offset:1024
    buffer_load_dwordx4 v[72:75], v3, s[16:19], s31 offen offset:1024
    buffer_load_dwordx4 v[76:79], v3, s[16:19], s32 offen offset:1024
    buffer_load_dwordx4 v[80:83], v3, s[16:19], s28 offen offset:2048
    buffer_load_dwordx4 v[84:87], v3, s[16:19], s30 offen offset:2048
    buffer_load_dwordx4 v[88:91], v3, s[16:19], s29 offen offset:2048
    buffer_load_dwordx4 v[92:95], v3, s[16:19], s31 offen offset:2048
    buffer_load_dwordx4 v[96:99], v3, s[16:19], s32 offen offset:2048
    buffer_load_dwordx4 v[100:103], v3, s[16:19], s28 offen offset:3072
    buffer_load_dwordx4 v[104:107], v3, s[16:19], s30 offen offset:3072
    buffer_load_dwordx4 v[108:111], v3, s[16:19], s29 offen offset:3072
    buffer_load_dwordx4 v[112:115], v3, s[16:19], s31 offen offset:3072
    buffer_load_dwordx4 v[116:119], v3, s[16:19], s32 offen offset:3072
    s_add_u32 s28, s28, 4096
    s_add_u32 s30, s30, 4096
    s_add_u32 s29, s29, 4096
    s_add_u32 s31, s31, 4096
    s_add_u32 s32, s32, 4096
    buffer_load_dwordx4 v[120:123], v3, s[16:19], s28 offen offset:0
    buffer_load_dwordx4 v[124:127], v3, s[16:19], s30 offen offset:0
    buffer_load_dwordx4 v[128:131], v3, s[16:19], s29 offen offset:0
    buffer_load_dwordx4 v[132:135], v3, s[16:19], s31 offen offset:0
    buffer_load_dwordx4 v[136:139], v3, s[16:19], s32 offen offset:0
    buffer_load_dwordx4 v[140:143], v3, s[16:19], s28 offen offset:1024
    buffer_load_dwordx4 v[144:147], v3, s[16:19], s30 offen offset:1024
    buffer_load_dwordx4 v[148:151], v3, s[16:19], s29 offen offset:1024
    buffer_load_dwordx4 v[152:155], v3, s[16:19], s31 offen offset:1024
    buffer_load_dwordx4 v[156:159], v3, s[16:19], s32 offen offset:1024
    s_cmp_ge_u32 s24, 3
    s_cselect_b32 s33, 1, 0
    s_mul_i32 s34, s33, 3
    s_sub_u32 s34, s24, s34
    s_lshl_b32 s35, s25, 1
    s_add_u32 s35, s35, s33
    s_mul_i32 s36, s26, 3
    s_add_u32 s36, s36, s34
    s_mul_i32 s37, s35, 18
    s_add_u32 s37, s37, s36
    s_lshl_b32 s37, s37, 11
    s_add_u32 s37, s37, 31145984
    v_and_b32 v4, 31, v1
    v_lshlrev_b32 v4, 2, v4
    s_lshl_b32 s38, s35, 7
    s_add_u32 s38, s38, 28114944
    v_lshrrev_b32 v5, 5, v1
    v_lshlrev_b32 v5, 3, v5
    s_lshl_b32 s39, s36, 6
    v_mov_b32 v160, 0
    v_mov_b32 v161, 0
    v_mov_b32 v162, 0
    v_mov_b32 v163, 0
    v_mov_b32 v164, 0
    v_mov_b32 v165, 0
    v_mov_b32 v166, 0
    v_mov_b32 v167, 0
    v_mov_b32 v168, 0
    v_mov_b32 v169, 0
    v_mov_b32 v170, 0
    v_mov_b32 v171, 0
    v_mov_b32 v172, 0
    v_mov_b32 v173, 0
    v_mov_b32 v174, 0
    v_mov_b32 v175, 0
    v_mov_b32 v176, 0
    v_mov_b32 v177, 0
    v_mov_b32 v178, 0
    v_mov_b32 v179, 0
    v_mov_b32 v180, 0
    v_mov_b32 v181, 0
    v_mov_b32 v182, 0
    v_mov_b32 v183, 0
    v_mov_b32 v184, 0
    v_mov_b32 v185, 0
    v_mov_b32 v186, 0
    v_mov_b32 v187, 0
    v_mov_b32 v188, 0
    v_mov_b32 v189, 0
    v_mov_b32 v190, 0
    v_mov_b32 v191, 0
    v_mov_b32 v192, 0
    v_mov_b32 v193, 0
    v_mov_b32 v194, 0
    v_mov_b32 v195, 0
    v_mov_b32 v196, 0
    v_mov_b32 v197, 0
    v_mov_b32 v198, 0
    v_mov_b32 v199, 0
    v_mov_b32 v200, 0
    v_mov_b32 v201, 0
    v_mov_b32 v202, 0
    v_mov_b32 v203, 0
    v_mov_b32 v204, 0
    v_mov_b32 v205, 0
    v_mov_b32 v206, 0
    v_mov_b32 v207, 0
    v_mov_b32 v208, 0
    v_mov_b32 v209, 0
    v_mov_b32 v210, 0
    v_mov_b32 v211, 0
    v_mov_b32 v212, 0
    v_mov_b32 v213, 0
    v_mov_b32 v214, 0
    v_mov_b32 v215, 0
    v_mov_b32 v216, 0
    v_mov_b32 v217, 0
    v_mov_b32 v218, 0
    v_mov_b32 v219, 0
    v_mov_b32 v220, 0
    v_mov_b32 v221, 0
    v_mov_b32 v222, 0
    v_mov_b32 v223, 0
    v_mov_b32 v224, 0
    v_mov_b32 v225, 0
    v_mov_b32 v226, 0
    v_mov_b32 v227, 0
    v_mov_b32 v228, 0
    v_mov_b32 v229, 0
    v_mov_b32 v230, 0
    v_mov_b32 v231, 0
    v_mov_b32 v232, 0
    v_mov_b32 v233, 0
    v_mov_b32 v234, 0
    v_mov_b32 v235, 0
    v_mov_b32 v236, 0
    v_mov_b32 v237, 0
    v_mov_b32 v238, 0
    v_mov_b32 v239, 0
    v_mov_b32 v240, 0
    v_mov_b32 v241, 0
    v_mov_b32 v242, 0
    v_mov_b32 v243, 0
    v_mov_b32 v244, 0
    v_mov_b32 v245, 0
    v_mov_b32 v246, 0
    v_mov_b32 v247, 0
    v_mov_b32 v248, 0
    v_mov_b32 v249, 0
    v_mov_b32 v250, 0
    v_mov_b32 v251, 0
    v_mov_b32 v252, 0
    v_mov_b32 v253, 0
    v_mov_b32 v254, 0
    v_mov_b32 v255, 0
    s_nop 1
    s_waitcnt vmcnt(25)
    v_mfma_f32_32x32x16_bf16 v[160:175], v[48:51], v[40:43], v[160:175]
    v_mfma_f32_32x32x16_bf16 v[176:191], v[52:55], v[40:43], v[176:191]
    v_mfma_f32_32x32x16_bf16 v[192:207], v[56:59], v[40:43], v[192:207]
    v_mfma_f32_32x32x16_bf16 v[208:223], v[48:51], v[44:47], v[208:223]
    v_mfma_f32_32x32x16_bf16 v[224:239], v[52:55], v[44:47], v[224:239]
    v_mfma_f32_32x32x16_bf16 v[240:255], v[56:59], v[44:47], v[240:255]
    s_waitcnt vmcnt(20)
    v_mfma_f32_32x32x16_bf16 v[160:175], v[68:71], v[60:63], v[160:175]
    v_mfma_f32_32x32x16_bf16 v[176:191], v[72:75], v[60:63], v[176:191]
    v_mfma_f32_32x32x16_bf16 v[192:207], v[76:79], v[60:63], v[192:207]
    v_mfma_f32_32x32x16_bf16 v[208:223], v[68:71], v[64:67], v[208:223]
    v_mfma_f32_32x32x16_bf16 v[224:239], v[72:75], v[64:67], v[224:239]
    v_mfma_f32_32x32x16_bf16 v[240:255], v[76:79], v[64:67], v[240:255]
    s_waitcnt vmcnt(15)
    v_mfma_f32_32x32x16_bf16 v[160:175], v[88:91], v[80:83], v[160:175]
    v_mfma_f32_32x32x16_bf16 v[176:191], v[92:95], v[80:83], v[176:191]
    v_mfma_f32_32x32x16_bf16 v[192:207], v[96:99], v[80:83], v[192:207]
    v_mfma_f32_32x32x16_bf16 v[208:223], v[88:91], v[84:87], v[208:223]
    v_mfma_f32_32x32x16_bf16 v[224:239], v[92:95], v[84:87], v[224:239]
    v_mfma_f32_32x32x16_bf16 v[240:255], v[96:99], v[84:87], v[240:255]
    s_nop 7
    buffer_load_dwordx4 v[40:43], v3, s[16:19], s37 offen
    buffer_load_dwordx4 v[44:47], v3, s[16:19], s37 offen offset:1024
    s_add_u32 s37, s37, 2359296
    buffer_load_dwordx4 v[48:51], v3, s[16:19], s37 offen
    buffer_load_dwordx4 v[52:55], v3, s[16:19], s37 offen offset:1024
    s_add_u32 s37, s37, 2359296
    buffer_load_dwordx4 v[56:59], v3, s[16:19], s37 offen
    buffer_load_dwordx4 v[60:63], v3, s[16:19], s37 offen offset:1024
    s_add_u32 s37, s37, 2359296
    buffer_load_dwordx4 v[64:67], v3, s[16:19], s37 offen
    buffer_load_dwordx4 v[68:71], v3, s[16:19], s37 offen offset:1024
    s_add_u32 s37, s37, 2359296
    buffer_load_dwordx4 v[72:75], v3, s[16:19], s37 offen
    buffer_load_dwordx4 v[76:79], v3, s[16:19], s37 offen offset:1024
    buffer_load_dwordx2 v[16:17], v5, s[12:15], s39 offen offset:0
    buffer_load_dwordx2 v[18:19], v5, s[12:15], s39 offen offset:16
    buffer_load_dwordx2 v[20:21], v5, s[12:15], s39 offen offset:32
    buffer_load_dwordx2 v[22:23], v5, s[12:15], s39 offen offset:48
    buffer_load_dword v6, v4, s[16:19], s38 offen
    s_waitcnt vmcnt(25)
    v_mfma_f32_32x32x16_bf16 v[160:175], v[108:111], v[100:103], v[160:175]
    v_mfma_f32_32x32x16_bf16 v[176:191], v[112:115], v[100:103], v[176:191]
    v_mfma_f32_32x32x16_bf16 v[192:207], v[116:119], v[100:103], v[192:207]
    v_mfma_f32_32x32x16_bf16 v[208:223], v[108:111], v[104:107], v[208:223]
    v_mfma_f32_32x32x16_bf16 v[224:239], v[112:115], v[104:107], v[224:239]
    v_mfma_f32_32x32x16_bf16 v[240:255], v[116:119], v[104:107], v[240:255]
    s_waitcnt vmcnt(20)
    v_mfma_f32_32x32x16_bf16 v[160:175], v[128:131], v[120:123], v[160:175]
    v_mfma_f32_32x32x16_bf16 v[176:191], v[132:135], v[120:123], v[176:191]
    v_mfma_f32_32x32x16_bf16 v[192:207], v[136:139], v[120:123], v[192:207]
    v_mfma_f32_32x32x16_bf16 v[208:223], v[128:131], v[124:127], v[208:223]
    v_mfma_f32_32x32x16_bf16 v[224:239], v[132:135], v[124:127], v[224:239]
    v_mfma_f32_32x32x16_bf16 v[240:255], v[136:139], v[124:127], v[240:255]
    s_waitcnt vmcnt(15)
    v_mfma_f32_32x32x16_bf16 v[160:175], v[148:151], v[140:143], v[160:175]
    v_mfma_f32_32x32x16_bf16 v[176:191], v[152:155], v[140:143], v[176:191]
    v_mfma_f32_32x32x16_bf16 v[192:207], v[156:159], v[140:143], v[192:207]
    v_mfma_f32_32x32x16_bf16 v[208:223], v[148:151], v[144:147], v[208:223]
    v_mfma_f32_32x32x16_bf16 v[224:239], v[152:155], v[144:147], v[224:239]
    v_mfma_f32_32x32x16_bf16 v[240:255], v[156:159], v[144:147], v[240:255]
    s_nop 15
    s_nop 7
    s_mul_i32 s40, s24, 4096
    v_add_u32 v7, s40, v3
    ds_write_b128 v7, v[160:163] offset:0
    ds_write_b128 v7, v[164:167] offset:1024
    ds_write_b128 v7, v[168:171] offset:2048
    ds_write_b128 v7, v[172:175] offset:3072
    ds_write_b128 v7, v[176:179] offset:24576
    ds_write_b128 v7, v[180:183] offset:25600
    ds_write_b128 v7, v[184:187] offset:26624
    ds_write_b128 v7, v[188:191] offset:27648
    v_add_u32 v7, 49152, v7
    ds_write_b128 v7, v[192:195] offset:0
    ds_write_b128 v7, v[196:199] offset:1024
    ds_write_b128 v7, v[200:203] offset:2048
    ds_write_b128 v7, v[204:207] offset:3072
    ds_write_b128 v7, v[208:211] offset:24576
    ds_write_b128 v7, v[212:215] offset:25600
    ds_write_b128 v7, v[216:219] offset:26624
    ds_write_b128 v7, v[220:223] offset:27648
    v_add_u32 v7, 49152, v7
    ds_write_b128 v7, v[224:227] offset:0
    ds_write_b128 v7, v[228:231] offset:1024
    ds_write_b128 v7, v[232:235] offset:2048
    ds_write_b128 v7, v[236:239] offset:3072
    ds_write_b128 v7, v[240:243] offset:24576
    ds_write_b128 v7, v[244:247] offset:25600
    ds_write_b128 v7, v[248:251] offset:26624
    ds_write_b128 v7, v[252:255] offset:27648
    s_waitcnt lgkmcnt(0)
    s_barrier
    s_mul_i32 s40, s24, 24576
    v_add_u32 v7, s40, v3
    ds_read_b128 v[160:163], v7 offset:0
    ds_read_b128 v[164:167], v7 offset:1024
    ds_read_b128 v[168:171], v7 offset:2048
    ds_read_b128 v[172:175], v7 offset:3072
    ds_read_b128 v[176:179], v7 offset:4096
    ds_read_b128 v[180:183], v7 offset:5120
    ds_read_b128 v[184:187], v7 offset:6144
    ds_read_b128 v[188:191], v7 offset:7168
    ds_read_b128 v[192:195], v7 offset:8192
    ds_read_b128 v[196:199], v7 offset:9216
    ds_read_b128 v[200:203], v7 offset:10240
    ds_read_b128 v[204:207], v7 offset:11264
    ds_read_b128 v[208:211], v7 offset:12288
    ds_read_b128 v[212:215], v7 offset:13312
    ds_read_b128 v[216:219], v7 offset:14336
    ds_read_b128 v[220:223], v7 offset:15360
    ds_read_b128 v[224:227], v7 offset:16384
    ds_read_b128 v[228:231], v7 offset:17408
    ds_read_b128 v[232:235], v7 offset:18432
    ds_read_b128 v[236:239], v7 offset:19456
    ds_read_b128 v[240:243], v7 offset:20480
    ds_read_b128 v[244:247], v7 offset:21504
    ds_read_b128 v[248:251], v7 offset:22528
    ds_read_b128 v[252:255], v7 offset:23552
    s_waitcnt vmcnt(0)
    v_lshlrev_b32 v100, 16, v16
    v_and_b32 v101, 0xffff0000, v16
    v_lshlrev_b32 v8, 16, v40
    v_and_b32 v9, 0xffff0000, v40
    v_pk_add_f32 v[100:101], v[100:101], v[8:9]
    v_lshlrev_b32 v8, 16, v48
    v_and_b32 v9, 0xffff0000, v48
    v_pk_add_f32 v[100:101], v[100:101], v[8:9]
    v_lshlrev_b32 v8, 16, v56
    v_and_b32 v9, 0xffff0000, v56
    v_pk_add_f32 v[100:101], v[100:101], v[8:9]
    v_lshlrev_b32 v8, 16, v64
    v_and_b32 v9, 0xffff0000, v64
    v_pk_add_f32 v[100:101], v[100:101], v[8:9]
    v_lshlrev_b32 v8, 16, v72
    v_and_b32 v9, 0xffff0000, v72
    v_pk_add_f32 v[100:101], v[100:101], v[8:9]
    v_lshlrev_b32 v102, 16, v17
    v_and_b32 v103, 0xffff0000, v17
    v_lshlrev_b32 v8, 16, v41
    v_and_b32 v9, 0xffff0000, v41
    v_pk_add_f32 v[102:103], v[102:103], v[8:9]
    v_lshlrev_b32 v8, 16, v49
    v_and_b32 v9, 0xffff0000, v49
    v_pk_add_f32 v[102:103], v[102:103], v[8:9]
    v_lshlrev_b32 v8, 16, v57
    v_and_b32 v9, 0xffff0000, v57
    v_pk_add_f32 v[102:103], v[102:103], v[8:9]
    v_lshlrev_b32 v8, 16, v65
    v_and_b32 v9, 0xffff0000, v65
    v_pk_add_f32 v[102:103], v[102:103], v[8:9]
    v_lshlrev_b32 v8, 16, v73
    v_and_b32 v9, 0xffff0000, v73
    v_pk_add_f32 v[102:103], v[102:103], v[8:9]
    v_lshlrev_b32 v104, 16, v18
    v_and_b32 v105, 0xffff0000, v18
    v_lshlrev_b32 v8, 16, v42
    v_and_b32 v9, 0xffff0000, v42
    v_pk_add_f32 v[104:105], v[104:105], v[8:9]
    v_lshlrev_b32 v8, 16, v50
    v_and_b32 v9, 0xffff0000, v50
    v_pk_add_f32 v[104:105], v[104:105], v[8:9]
    v_lshlrev_b32 v8, 16, v58
    v_and_b32 v9, 0xffff0000, v58
    v_pk_add_f32 v[104:105], v[104:105], v[8:9]
    v_lshlrev_b32 v8, 16, v66
    v_and_b32 v9, 0xffff0000, v66
    v_pk_add_f32 v[104:105], v[104:105], v[8:9]
    v_lshlrev_b32 v8, 16, v74
    v_and_b32 v9, 0xffff0000, v74
    v_pk_add_f32 v[104:105], v[104:105], v[8:9]
    v_lshlrev_b32 v106, 16, v19
    v_and_b32 v107, 0xffff0000, v19
    v_lshlrev_b32 v8, 16, v43
    v_and_b32 v9, 0xffff0000, v43
    v_pk_add_f32 v[106:107], v[106:107], v[8:9]
    v_lshlrev_b32 v8, 16, v51
    v_and_b32 v9, 0xffff0000, v51
    v_pk_add_f32 v[106:107], v[106:107], v[8:9]
    v_lshlrev_b32 v8, 16, v59
    v_and_b32 v9, 0xffff0000, v59
    v_pk_add_f32 v[106:107], v[106:107], v[8:9]
    v_lshlrev_b32 v8, 16, v67
    v_and_b32 v9, 0xffff0000, v67
    v_pk_add_f32 v[106:107], v[106:107], v[8:9]
    v_lshlrev_b32 v8, 16, v75
    v_and_b32 v9, 0xffff0000, v75
    v_pk_add_f32 v[106:107], v[106:107], v[8:9]
    v_lshlrev_b32 v108, 16, v20
    v_and_b32 v109, 0xffff0000, v20
    v_lshlrev_b32 v8, 16, v44
    v_and_b32 v9, 0xffff0000, v44
    v_pk_add_f32 v[108:109], v[108:109], v[8:9]
    v_lshlrev_b32 v8, 16, v52
    v_and_b32 v9, 0xffff0000, v52
    v_pk_add_f32 v[108:109], v[108:109], v[8:9]
    v_lshlrev_b32 v8, 16, v60
    v_and_b32 v9, 0xffff0000, v60
    v_pk_add_f32 v[108:109], v[108:109], v[8:9]
    v_lshlrev_b32 v8, 16, v68
    v_and_b32 v9, 0xffff0000, v68
    v_pk_add_f32 v[108:109], v[108:109], v[8:9]
    v_lshlrev_b32 v8, 16, v76
    v_and_b32 v9, 0xffff0000, v76
    v_pk_add_f32 v[108:109], v[108:109], v[8:9]
    v_lshlrev_b32 v110, 16, v21
    v_and_b32 v111, 0xffff0000, v21
    v_lshlrev_b32 v8, 16, v45
    v_and_b32 v9, 0xffff0000, v45
    v_pk_add_f32 v[110:111], v[110:111], v[8:9]
    v_lshlrev_b32 v8, 16, v53
    v_and_b32 v9, 0xffff0000, v53
    v_pk_add_f32 v[110:111], v[110:111], v[8:9]
    v_lshlrev_b32 v8, 16, v61
    v_and_b32 v9, 0xffff0000, v61
    v_pk_add_f32 v[110:111], v[110:111], v[8:9]
    v_lshlrev_b32 v8, 16, v69
    v_and_b32 v9, 0xffff0000, v69
    v_pk_add_f32 v[110:111], v[110:111], v[8:9]
    v_lshlrev_b32 v8, 16, v77
    v_and_b32 v9, 0xffff0000, v77
    v_pk_add_f32 v[110:111], v[110:111], v[8:9]
    v_lshlrev_b32 v112, 16, v22
    v_and_b32 v113, 0xffff0000, v22
    v_lshlrev_b32 v8, 16, v46
    v_and_b32 v9, 0xffff0000, v46
    v_pk_add_f32 v[112:113], v[112:113], v[8:9]
    v_lshlrev_b32 v8, 16, v54
    v_and_b32 v9, 0xffff0000, v54
    v_pk_add_f32 v[112:113], v[112:113], v[8:9]
    v_lshlrev_b32 v8, 16, v62
    v_and_b32 v9, 0xffff0000, v62
    v_pk_add_f32 v[112:113], v[112:113], v[8:9]
    v_lshlrev_b32 v8, 16, v70
    v_and_b32 v9, 0xffff0000, v70
    v_pk_add_f32 v[112:113], v[112:113], v[8:9]
    v_lshlrev_b32 v8, 16, v78
    v_and_b32 v9, 0xffff0000, v78
    v_pk_add_f32 v[112:113], v[112:113], v[8:9]
    v_lshlrev_b32 v114, 16, v23
    v_and_b32 v115, 0xffff0000, v23
    v_lshlrev_b32 v8, 16, v47
    v_and_b32 v9, 0xffff0000, v47
    v_pk_add_f32 v[114:115], v[114:115], v[8:9]
    v_lshlrev_b32 v8, 16, v55
    v_and_b32 v9, 0xffff0000, v55
    v_pk_add_f32 v[114:115], v[114:115], v[8:9]
    v_lshlrev_b32 v8, 16, v63
    v_and_b32 v9, 0xffff0000, v63
    v_pk_add_f32 v[114:115], v[114:115], v[8:9]
    v_lshlrev_b32 v8, 16, v71
    v_and_b32 v9, 0xffff0000, v71
    v_pk_add_f32 v[114:115], v[114:115], v[8:9]
    v_lshlrev_b32 v8, 16, v79
    v_and_b32 v9, 0xffff0000, v79
    v_pk_add_f32 v[114:115], v[114:115], v[8:9]
    v_sub_f32 v10, 1.0, v6
    s_waitcnt lgkmcnt(0)
    v_pk_add_f32 v[160:161], v[160:161], v[176:177]
    v_pk_add_f32 v[162:163], v[162:163], v[178:179]
    v_pk_add_f32 v[164:165], v[164:165], v[180:181]
    v_pk_add_f32 v[166:167], v[166:167], v[182:183]
    v_pk_add_f32 v[168:169], v[168:169], v[184:185]
    v_pk_add_f32 v[170:171], v[170:171], v[186:187]
    v_pk_add_f32 v[172:173], v[172:173], v[188:189]
    v_pk_add_f32 v[174:175], v[174:175], v[190:191]
    v_pk_add_f32 v[160:161], v[160:161], v[192:193]
    v_pk_add_f32 v[162:163], v[162:163], v[194:195]
    v_pk_add_f32 v[164:165], v[164:165], v[196:197]
    v_pk_add_f32 v[166:167], v[166:167], v[198:199]
    v_pk_add_f32 v[168:169], v[168:169], v[200:201]
    v_pk_add_f32 v[170:171], v[170:171], v[202:203]
    v_pk_add_f32 v[172:173], v[172:173], v[204:205]
    v_pk_add_f32 v[174:175], v[174:175], v[206:207]
    v_pk_add_f32 v[160:161], v[160:161], v[208:209]
    v_pk_add_f32 v[162:163], v[162:163], v[210:211]
    v_pk_add_f32 v[164:165], v[164:165], v[212:213]
    v_pk_add_f32 v[166:167], v[166:167], v[214:215]
    v_pk_add_f32 v[168:169], v[168:169], v[216:217]
    v_pk_add_f32 v[170:171], v[170:171], v[218:219]
    v_pk_add_f32 v[172:173], v[172:173], v[220:221]
    v_pk_add_f32 v[174:175], v[174:175], v[222:223]
    v_pk_add_f32 v[160:161], v[160:161], v[224:225]
    v_pk_add_f32 v[162:163], v[162:163], v[226:227]
    v_pk_add_f32 v[164:165], v[164:165], v[228:229]
    v_pk_add_f32 v[166:167], v[166:167], v[230:231]
    v_pk_add_f32 v[168:169], v[168:169], v[232:233]
    v_pk_add_f32 v[170:171], v[170:171], v[234:235]
    v_pk_add_f32 v[172:173], v[172:173], v[236:237]
    v_pk_add_f32 v[174:175], v[174:175], v[238:239]
    v_pk_add_f32 v[160:161], v[160:161], v[240:241]
    v_pk_add_f32 v[162:163], v[162:163], v[242:243]
    v_pk_add_f32 v[164:165], v[164:165], v[244:245]
    v_pk_add_f32 v[166:167], v[166:167], v[246:247]
    v_pk_add_f32 v[168:169], v[168:169], v[248:249]
    v_pk_add_f32 v[170:171], v[170:171], v[250:251]
    v_pk_add_f32 v[172:173], v[172:173], v[252:253]
    v_pk_add_f32 v[174:175], v[174:175], v[254:255]
    v_mul_f32 v100, v10, v100
    v_mul_f32 v101, v10, v101
    v_mul_f32 v102, v10, v102
    v_mul_f32 v103, v10, v103
    v_mul_f32 v104, v10, v104
    v_mul_f32 v105, v10, v105
    v_mul_f32 v106, v10, v106
    v_mul_f32 v107, v10, v107
    v_mul_f32 v108, v10, v108
    v_mul_f32 v109, v10, v109
    v_mul_f32 v110, v10, v110
    v_mul_f32 v111, v10, v111
    v_mul_f32 v112, v10, v112
    v_mul_f32 v113, v10, v113
    v_mul_f32 v114, v10, v114
    v_mul_f32 v115, v10, v115
    v_fma_f32 v160, v6, v160, v100
    v_fma_f32 v161, v6, v161, v101
    v_fma_f32 v162, v6, v162, v102
    v_fma_f32 v163, v6, v163, v103
    v_fma_f32 v164, v6, v164, v104
    v_fma_f32 v165, v6, v165, v105
    v_fma_f32 v166, v6, v166, v106
    v_fma_f32 v167, v6, v167, v107
    v_fma_f32 v168, v6, v168, v108
    v_fma_f32 v169, v6, v169, v109
    v_fma_f32 v170, v6, v170, v110
    v_fma_f32 v171, v6, v171, v111
    v_fma_f32 v172, v6, v172, v112
    v_fma_f32 v173, v6, v173, v113
    v_fma_f32 v174, v6, v174, v114
    v_fma_f32 v175, v6, v175, v115
    v_cvt_pk_bf16_f32 v120, v160, v161
    v_cvt_pk_bf16_f32 v121, v162, v163
    v_cvt_pk_bf16_f32 v122, v164, v165
    v_cvt_pk_bf16_f32 v123, v166, v167
    v_cvt_pk_bf16_f32 v124, v168, v169
    v_cvt_pk_bf16_f32 v125, v170, v171
    v_cvt_pk_bf16_f32 v126, v172, v173
    v_cvt_pk_bf16_f32 v127, v174, v175
    s_nop 1
    v_permlane32_swap_b32 v120, v122
    v_permlane32_swap_b32 v121, v123
    v_permlane32_swap_b32 v124, v126
    v_permlane32_swap_b32 v125, v127
    s_nop 1
    v_permlane16_swap_b32 v120, v124
    v_permlane16_swap_b32 v121, v125
    v_permlane16_swap_b32 v122, v126
    v_permlane16_swap_b32 v123, v127
    v_and_b32 v4, 15, v1
    v_mul_u32_u24 v4, 1152, v4
    v_lshrrev_b32 v5, 5, v1
    v_lshl_add_u32 v4, v5, 4, v4
    v_bfe_u32 v5, v1, 4, 1
    v_lshl_add_u32 v4, v5, 5, v4
    s_mul_i32 s38, s35, 36864
    s_lshl_b32 s39, s36, 6
    s_add_u32 s38, s38, s39
    s_add_u32 s39, s38, 18432
    s_nop 1
    buffer_store_dwordx4 v[120:123], v4, s[8:11], s38 offen nt
    buffer_store_dwordx4 v[124:127], v4, s[8:11], s39 offen nt
k3_end:
    s_endpgm
.section .rodata,"a"
.p2align 6
.amdhsa_kernel k1_kernel
  .amdhsa_next_free_vgpr 240
  .amdhsa_next_free_sgpr 96
  .amdhsa_accum_offset 240
  .amdhsa_group_segment_fixed_size 0
  .amdhsa_kernarg_size 96
  .amdhsa_user_sgpr_count 2
  .amdhsa_user_sgpr_kernarg_segment_ptr 1
  .amdhsa_system_sgpr_workgroup_id_x 1
.end_amdhsa_kernel
.section .rodata,"a"
.p2align 6
.amdhsa_kernel k2_kernel
  .amdhsa_next_free_vgpr 256
  .amdhsa_next_free_sgpr 96
  .amdhsa_accum_offset 256
  .amdhsa_group_segment_fixed_size 0
  .amdhsa_kernarg_size 96
  .amdhsa_user_sgpr_count 2
  .amdhsa_user_sgpr_kernarg_segment_ptr 1
  .amdhsa_system_sgpr_workgroup_id_x 1
.end_amdhsa_kernel
.section .rodata,"a"
.p2align 6
.amdhsa_kernel k3_kernel
  .amdhsa_next_free_vgpr 256
  .amdhsa_next_free_sgpr 96
  .amdhsa_accum_offset 256
  .amdhsa_group_segment_fixed_size 0
  .amdhsa_kernarg_size 96
  .amdhsa_user_sgpr_count 2
  .amdhsa_user_sgpr_kernarg_segment_ptr 1
  .amdhsa_system_sgpr_workgroup_id_x 1
.end_amdhsa_kernel
```
